```python
import torch

def _softmax(x, axis=-1):
    return torch.softmax(x, dim=axis)
def _gelu(x):
    return torch.nn.functional.gelu(x, approximate="tanh")
def _silu(x):
    return torch.nn.functional.silu(x)
def _sigmoid(x):
    return torch.sigmoid(x)
def _layernorm(x, axis=-1, eps=1e-5):
    m = x.mean(dim=axis, keepdim=True)
    v = x.var(dim=axis, keepdim=True, unbiased=False)
    return (x - m) / torch.sqrt(v + eps)
def _scatter_add(tgt, idx, src, axis=0):
    return tgt.clone().index_add_(axis, idx, src)
def _segment_sum(src, seg, n):
    out = torch.zeros((n,) + src.shape[1:], dtype=src.dtype)
    return out.index_add_(0, seg, src)
def _pad(x, pw):
    flat = tuple(v for pair in reversed(pw) for v in pair)
    return torch.nn.functional.pad(x, flat)

kernel_name = 'gated_mix__ssm_conv_s4__dense_activation_silu__prompt'

def setup_inputs():

    _w = (lambda a: (lambda t: t.to(torch.bfloat16) if t.is_floating_point() else t)(torch.as_tensor(a)))
    def _A_setup():
        B, L, D, N = 1, 2048, 512, 128
        A_re = -(lambda _x: torch.exp(torch.as_tensor(_x)))((lambda *s: torch.randn(*s, dtype=torch.bfloat16) * 6.4)(D, N))
        A_im = torch.pi * (lambda *s: torch.randn(*s, dtype=torch.bfloat16) * 0.05)(D, N)
        B_re = (lambda *s: torch.randn(*s, dtype=torch.bfloat16) * 0.2)(D, N)
        B_im = (lambda *s: torch.randn(*s, dtype=torch.bfloat16) * 0.2)(D, N)
        C_re = (lambda *s: torch.randn(*s, dtype=torch.bfloat16) * 0.2)(D, N)
        C_im = (lambda *s: torch.randn(*s, dtype=torch.bfloat16) * 0.2)(D, N)
        log_dt = (lambda *s: torch.randn(*s, dtype=torch.bfloat16) * 0.05)(D) * 0.5 - 4.0
        Dskip = (lambda *s: torch.randn(*s, dtype=torch.bfloat16) * 0.05)(D)
        return {
            "u": _w((lambda *s: torch.randn(*s, dtype=torch.bfloat16) * 0.05)(B, L, D)),
            "A_re": _w(A_re),
            "A_im": _w(A_im),
            "B_re": _w(B_re),
            "B_im": _w(B_im),
            "C_re": _w(C_re),
            "C_im": _w(C_im),
            "log_dt": _w(log_dt),
            "Dskip": _w(Dskip),
        }
    _A_in = _A_setup()

    def _B_setup():
        B, S, D, F = 1, 2048, 512, 1792
        return {
            "x": _w((lambda *s: torch.randn(*s, dtype=torch.bfloat16) * 0.05)(B, S, D)),
            "w1": _w((lambda *s: torch.randn(*s, dtype=torch.bfloat16) * 6.4)(D, F) * (D ** -0.5)),
            "w2": _w((lambda *s: torch.randn(*s, dtype=torch.bfloat16) * 0.2)(F, D) * (F ** -0.5)),
        }
    _B_in = _B_setup()

    return {
        "A_u": _A_in["u"],
        "A_A_re": _A_in["A_re"],
        "A_A_im": _A_in["A_im"],
        "A_B_re": _A_in["B_re"],
        "A_B_im": _A_in["B_im"],
        "A_C_re": _A_in["C_re"],
        "A_C_im": _A_in["C_im"],
        "A_log_dt": _A_in["log_dt"],
        "A_Dskip": _A_in["Dskip"],
        "B_x": _B_in["x"],
        "B_w1": _B_in["w1"],
        "B_w2": _B_in["w2"],
        "gate_w": _w((lambda *s: torch.randn(*s, dtype=torch.bfloat16) * 0.05)(512) * 16.0),
    }

def reference(A_u, A_A_re, A_A_im, A_B_re, A_B_im, A_C_re, A_C_im, A_log_dt, A_Dskip, B_x, B_w1, B_w2, gate_w):
    def _A_ref(u, A_re, A_im, B_re, B_im, C_re, C_im, log_dt, Dskip):
        Bsz, L, D = u.shape
        dt = torch.exp(log_dt)[:, None]
        A = A_re + 1j * A_im
        Bc = B_re + 1j * B_im
        Cc = C_re + 1j * C_im
        logdA = dt * A
        dB = dt * Bc
        l = (lambda x, dt: x.to(dt))(torch.arange(L), A_re.dtype)
        P = torch.exp(logdA[:, :, None] * l[None, None, :])
        K = torch.einsum("dn,dnl,dn->dl", Cc, P, dB).real
        L2 = 2 * L
        Kp = _pad(K, ((0, 0), (0, L)))
        up = (lambda x, *d: x.permute(*d))(u, 0, 2, 1)
        up = _pad(up, ((0, 0), (0, 0), (0, L)))
        Kf = (lambda x, axes=(-2,-1): torch.fft.rfft2(x.float(), dim=axes))(Kp[:, None, :], axes=(-2, -1))
        Uf = (lambda x, axes=(-2,-1): torch.fft.rfft2(x.float(), dim=axes))(up[:, :, None, :], axes=(-2, -1))
        Yf = Uf * Kf[None, :, :, :]
        y = (lambda x, s, axes=(-2,-1): torch.fft.irfft2(x, s=s, dim=axes).to(torch.bfloat16))(Yf, (1, L2), axes=(-2, -1))[:, :, 0, :L]
        y = (lambda x, *d: x.permute(*d))(y, 0, 2, 1) + u * Dskip[None, None, :]
        return y

    def _B_ref(x, w1, w2):
        h = torch.einsum("bsd,df->bsf", x, w1)
        h = _silu(h)
        out = torch.einsum("bsf,fd->bsd", h, w2)
        return out

    x = A_u
    g = _sigmoid((x * gate_w).sum(-1, keepdims=True))
    a = _A_ref(x, A_A_re, A_A_im, A_B_re, A_B_im, A_C_re, A_C_im, A_log_dt, A_Dskip)
    b = _B_ref(x, B_w1, B_w2)
    return g * a + (1 - g) * b
```

```asm
; @launch kernel=ka_kernel grid=(512,1,1) block=(256,1,1) lds=81920
; @launch kernel=kb_kernel grid=(256,1,1) block=(256,1,1) lds=73728
.amdgcn_target "amdgcn-amd-amdhsa--gfx950"
.text
.globl ka_kernel
.p2align 8
.type ka_kernel,@function
ka_kernel:
s_cmp_ge_u32 s2, 512
s_cbranch_scc1 L_ka_end
s_mov_b32 s3, s2
s_xor_b32 s2, s2, 256
s_cmp_ge_u32 s2, 256
s_cbranch_scc1 L_role_ssm
s_cmp_ge_u32 s2, 224
s_cbranch_scc1 L_role_side
s_load_dwordx2 s[4:5], s[0:1], 120
s_load_dwordx2 s[6:7], s[0:1], 0
s_load_dwordx2 s[8:9], s[0:1], 80
v_lshrrev_b32 v1, 6, v0
v_and_b32 v2, 63, v0
s_and_b32 s10, s2, 7
v_readfirstlane_b32 s11, v1
s_lshr_b32 s12, s2, 3
s_and_b32 s13, s12, 3
s_lshr_b32 s14, s10, 1
s_lshl_b32 s14, s14, 2
s_and_b32 s15, s10, 1
s_mul_i32 s15, s15, 7
s_lshr_b32 s12, s12, 2
s_add_u32 s10, s14, s13
s_add_u32 s12, s12, s15
s_lshl_b32 s13, s13, 1
v_lshrrev_b32 v6, 3, v2
v_and_b32 v7, 7, v2
v_lshrrev_b32 v8, 1, v6
v_xor_b32 v7, v7, v8
v_lshlrev_b32 v7, 4, v7
v_lshlrev_b32 v6, 10, v6
v_add_u32 v3, v6, v7
v_xor_b32 v5, 64, v3
v_lshrrev_b32 v6, 4, v2
v_and_b32 v7, 15, v2
v_lshrrev_b32 v8, 1, v7
v_lshlrev_b32 v9, 1, v6
v_xor_b32 v8, v8, v9
v_lshlrev_b32 v8, 1, v8
v_and_b32 v7, 1, v7
v_or_b32 v8, v8, v7
v_lshlrev_b32 v8, 4, v8
v_mul_u32_u24 v6, 3584, v6
v_add_u32 v4, v6, v8
s_lshl_b32 s14, s11, 15
s_add_u32 s40, s14, 0
s_add_u32 s41, s14, 7168
s_add_u32 s42, s14, 14336
s_add_u32 s43, s14, 21504
s_mul_i32 s14, s11, 57344
s_add_u32 s44, s14, 0
s_add_u32 s45, s14, 13312
s_add_u32 s46, s14, 26624
s_add_u32 s47, s14, 39936
s_lshl_b32 s15, s11, 12
s_lshl_b32 s16, s10, 17
s_lshl_b32 s17, s12, 8
s_sub_u32 s18, 1835008, s17
s_waitcnt lgkmcnt(0)
s_add_u32 s20, s6, s16
s_addc_u32 s21, s7, 0
s_and_b32 s21, s21, 0xffff
s_mov_b32 s22, 131072
s_mov_b32 s23, 0x20000
s_add_u32 s24, s8, s17
s_addc_u32 s25, s9, 0
s_and_b32 s25, s25, 0xffff
s_mov_b32 s26, s18
s_mov_b32 s27, 0x20000
s_and_b32 s48, s2, 7
s_add_u32 s48, s48, s13
s_add_u32 s48, s48, s12
s_and_b32 s48, s48, 7
s_mov_b32 s49, s48
s_add_u32 m0, s15, 0
s_lshl_b32 s54, s48, 7
s_add_u32 s50, s40, s54
s_add_u32 s51, s41, s54
s_add_u32 s52, s42, s54
s_add_u32 s53, s43, s54
s_add_u32 s48, s48, 1
s_and_b32 s48, s48, 7
buffer_load_dwordx4 v3, s[20:23], s50 offen offset:0 lds
buffer_load_dwordx4 v5, s[20:23], s51 offen offset:1024 lds
buffer_load_dwordx4 v3, s[20:23], s52 offen offset:2048 lds
buffer_load_dwordx4 v5, s[20:23], s53 offen offset:3072 lds
s_add_u32 m0, s15, 16384
s_mul_i32 s54, s49, 229376
s_add_u32 s56, s44, s54
s_add_u32 s57, s45, s54
s_add_u32 s58, s46, s54
s_add_u32 s59, s47, s54
s_add_u32 s49, s49, 1
s_and_b32 s49, s49, 7
buffer_load_dwordx4 v4, s[24:27], s56 offen offset:0 lds
buffer_load_dwordx4 v4, s[24:27], s57 offen offset:1024 lds
buffer_load_dwordx4 v4, s[24:27], s58 offen offset:2048 lds
buffer_load_dwordx4 v4, s[24:27], s59 offen offset:3072 lds
s_add_u32 m0, s15, 49152
s_mul_i32 s54, s49, 229376
s_add_u32 s56, s44, s54
s_add_u32 s57, s45, s54
s_add_u32 s58, s46, s54
s_add_u32 s59, s47, s54
s_add_u32 s49, s49, 1
s_and_b32 s49, s49, 7
buffer_load_dwordx4 v4, s[24:27], s56 offen offset:0 lds
buffer_load_dwordx4 v4, s[24:27], s57 offen offset:1024 lds
buffer_load_dwordx4 v4, s[24:27], s58 offen offset:2048 lds
buffer_load_dwordx4 v4, s[24:27], s59 offen offset:3072 lds
s_and_b32 s19, s11, 1
s_lshr_b32 s28, s11, 1
v_and_b32 v6, 31, v2
v_lshrrev_b32 v7, 5, v2
v_lshrrev_b32 v8, 1, v6
v_and_b32 v8, 7, v8
v_xor_b32 v8, v8, v7
v_lshlrev_b32 v8, 4, v8
v_lshlrev_b32 v9, 7, v6
v_add_u32 v8, v8, v9
s_lshl_b32 s29, s19, 13
v_add_u32 v8, s29, v8
v_xor_b32 v9, 32, v8
v_xor_b32 v10, 64, v8
v_xor_b32 v11, 96, v8
v_lshrrev_b32 v14, 2, v2
v_and_b32 v14, 3, v14
v_lshlrev_b32 v15, 3, v7
v_add_u32 v15, v15, v14
v_lshlrev_b32 v15, 8, v15
v_lshrrev_b32 v12, 4, v2
v_and_b32 v12, 1, v12
s_lshl_b32 s29, s28, 2
v_or_b32 v12, s29, v12
v_lshlrev_b32 v14, 1, v14
v_xor_b32 v12, v12, v14
v_lshlrev_b32 v12, 5, v12
v_add_u32 v12, v12, v15
v_and_b32 v14, 3, v2
v_lshlrev_b32 v14, 3, v14
v_add_u32 v12, v12, v14
v_xor_b32 v13, 64, v12
v_lshrrev_b32 v14, 4, v6
v_lshlrev_b32 v14, 10, v14
v_and_b32 v15, 15, v6
v_lshlrev_b32 v15, 4, v15
v_add_u32 v14, v14, v15
v_lshlrev_b32 v15, 8, v7
v_add_u32 v14, v14, v15
v_mov_b32 v128, 0
v_mov_b32 v129, 0
v_mov_b32 v130, 0
v_mov_b32 v131, 0
v_mov_b32 v132, 0
v_mov_b32 v133, 0
v_mov_b32 v134, 0
v_mov_b32 v135, 0
v_mov_b32 v136, 0
v_mov_b32 v137, 0
v_mov_b32 v138, 0
v_mov_b32 v139, 0
v_mov_b32 v140, 0
v_mov_b32 v141, 0
v_mov_b32 v142, 0
v_mov_b32 v143, 0
v_mov_b32 v144, 0
v_mov_b32 v145, 0
v_mov_b32 v146, 0
v_mov_b32 v147, 0
v_mov_b32 v148, 0
v_mov_b32 v149, 0
v_mov_b32 v150, 0
v_mov_b32 v151, 0
v_mov_b32 v152, 0
v_mov_b32 v153, 0
v_mov_b32 v154, 0
v_mov_b32 v155, 0
v_mov_b32 v156, 0
v_mov_b32 v157, 0
v_mov_b32 v158, 0
v_mov_b32 v159, 0
v_mov_b32 v160, 0
v_mov_b32 v161, 0
v_mov_b32 v162, 0
v_mov_b32 v163, 0
v_mov_b32 v164, 0
v_mov_b32 v165, 0
v_mov_b32 v166, 0
v_mov_b32 v167, 0
v_mov_b32 v168, 0
v_mov_b32 v169, 0
v_mov_b32 v170, 0
v_mov_b32 v171, 0
v_mov_b32 v172, 0
v_mov_b32 v173, 0
v_mov_b32 v174, 0
v_mov_b32 v175, 0
v_mov_b32 v176, 0
v_mov_b32 v177, 0
v_mov_b32 v178, 0
v_mov_b32 v179, 0
v_mov_b32 v180, 0
v_mov_b32 v181, 0
v_mov_b32 v182, 0
v_mov_b32 v183, 0
v_mov_b32 v184, 0
v_mov_b32 v185, 0
v_mov_b32 v186, 0
v_mov_b32 v187, 0
v_mov_b32 v188, 0
v_mov_b32 v189, 0
v_mov_b32 v190, 0
v_mov_b32 v191, 0
s_add_u32 m0, s15, 32768
s_lshl_b32 s54, s48, 7
s_add_u32 s50, s40, s54
s_add_u32 s51, s41, s54
s_add_u32 s52, s42, s54
s_add_u32 s53, s43, s54
s_add_u32 s48, s48, 1
s_and_b32 s48, s48, 7
buffer_load_dwordx4 v3, s[20:23], s50 offen offset:0 lds
buffer_load_dwordx4 v5, s[20:23], s51 offen offset:1024 lds
buffer_load_dwordx4 v3, s[20:23], s52 offen offset:2048 lds
buffer_load_dwordx4 v5, s[20:23], s53 offen offset:3072 lds
s_add_u32 m0, s15, 65536
s_lshl_b32 s54, s48, 7
s_add_u32 s50, s40, s54
s_add_u32 s51, s41, s54
s_add_u32 s52, s42, s54
s_add_u32 s53, s43, s54
s_add_u32 s48, s48, 1
s_and_b32 s48, s48, 7
buffer_load_dwordx4 v3, s[20:23], s50 offen offset:0 lds
buffer_load_dwordx4 v5, s[20:23], s51 offen offset:1024 lds
buffer_load_dwordx4 v3, s[20:23], s52 offen offset:2048 lds
buffer_load_dwordx4 v5, s[20:23], s53 offen offset:3072 lds
s_waitcnt vmcnt(12)
s_barrier
ds_read_b64_tr_b16 v[32:33], v12 offset:16384
ds_read_b64_tr_b16 v[34:35], v12 offset:17408
ds_read_b128 v[48:51], v8 offset:0
ds_read_b64_tr_b16 v[36:37], v13 offset:16384
ds_read_b64_tr_b16 v[38:39], v13 offset:17408
ds_read_b128 v[52:55], v8 offset:4096
ds_read_b64_tr_b16 v[40:41], v12 offset:20480
ds_read_b64_tr_b16 v[42:43], v12 offset:21504
ds_read_b128 v[56:59], v9 offset:0
ds_read_b64_tr_b16 v[44:45], v13 offset:20480
ds_read_b64_tr_b16 v[46:47], v13 offset:21504
ds_read_b128 v[60:63], v9 offset:4096
s_waitcnt lgkmcnt(0)
v_mfma_f32_32x32x16_bf16 v[128:143], v[32:35], v[48:51], v[128:143]
ds_read_b64_tr_b16 v[64:65], v12 offset:24576
ds_read_b64_tr_b16 v[66:67], v12 offset:25600
v_mfma_f32_32x32x16_bf16 v[144:159], v[32:35], v[52:55], v[144:159]
ds_read_b128 v[80:83], v10 offset:0
ds_read_b64_tr_b16 v[68:69], v13 offset:24576
v_mfma_f32_32x32x16_bf16 v[160:175], v[36:39], v[48:51], v[160:175]
ds_read_b64_tr_b16 v[70:71], v13 offset:25600
ds_read_b128 v[84:87], v10 offset:4096
v_mfma_f32_32x32x16_bf16 v[176:191], v[36:39], v[52:55], v[176:191]
ds_read_b64_tr_b16 v[72:73], v12 offset:28672
ds_read_b64_tr_b16 v[74:75], v12 offset:29696
v_mfma_f32_32x32x16_bf16 v[128:143], v[40:43], v[56:59], v[128:143]
ds_read_b128 v[88:91], v11 offset:0
ds_read_b64_tr_b16 v[76:77], v13 offset:28672
v_mfma_f32_32x32x16_bf16 v[144:159], v[40:43], v[60:63], v[144:159]
ds_read_b64_tr_b16 v[78:79], v13 offset:29696
ds_read_b128 v[92:95], v11 offset:4096
v_mfma_f32_32x32x16_bf16 v[160:175], v[44:47], v[56:59], v[160:175]
v_mfma_f32_32x32x16_bf16 v[176:191], v[44:47], v[60:63], v[176:191]
s_waitcnt lgkmcnt(0)
s_waitcnt vmcnt(4)
s_barrier
s_add_u32 m0, s15, 0
s_mul_i32 s54, s49, 229376
s_add_u32 s56, s44, s54
s_add_u32 s57, s45, s54
s_add_u32 s58, s46, s54
s_add_u32 s59, s47, s54
s_add_u32 s49, s49, 1
s_and_b32 s49, s49, 7
v_mfma_f32_32x32x16_bf16 v[128:143], v[64:67], v[80:83], v[128:143]
buffer_load_dwordx4 v4, s[24:27], s56 offen offset:0 lds
ds_read_b64_tr_b16 v[32:33], v12 offset:49152
ds_read_b64_tr_b16 v[34:35], v12 offset:50176
v_mfma_f32_32x32x16_bf16 v[144:159], v[64:67], v[84:87], v[144:159]
ds_read_b128 v[48:51], v8 offset:32768
ds_read_b64_tr_b16 v[36:37], v13 offset:49152
v_mfma_f32_32x32x16_bf16 v[160:175], v[68:71], v[80:83], v[160:175]
buffer_load_dwordx4 v4, s[24:27], s57 offen offset:1024 lds
ds_read_b64_tr_b16 v[38:39], v13 offset:50176
ds_read_b128 v[52:55], v8 offset:36864
v_mfma_f32_32x32x16_bf16 v[176:191], v[68:71], v[84:87], v[176:191]
ds_read_b64_tr_b16 v[40:41], v12 offset:53248
ds_read_b64_tr_b16 v[42:43], v12 offset:54272
v_mfma_f32_32x32x16_bf16 v[128:143], v[72:75], v[88:91], v[128:143]
buffer_load_dwordx4 v4, s[24:27], s58 offen offset:2048 lds
ds_read_b128 v[56:59], v9 offset:32768
ds_read_b64_tr_b16 v[44:45], v13 offset:53248
v_mfma_f32_32x32x16_bf16 v[144:159], v[72:75], v[92:95], v[144:159]
ds_read_b64_tr_b16 v[46:47], v13 offset:54272
ds_read_b128 v[60:63], v9 offset:36864
v_mfma_f32_32x32x16_bf16 v[160:175], v[76:79], v[88:91], v[160:175]
buffer_load_dwordx4 v4, s[24:27], s59 offen offset:3072 lds
v_mfma_f32_32x32x16_bf16 v[176:191], v[76:79], v[92:95], v[176:191]
s_waitcnt lgkmcnt(0)
s_add_u32 m0, s15, 16384
s_lshl_b32 s54, s48, 7
s_add_u32 s50, s40, s54
s_add_u32 s51, s41, s54
s_add_u32 s52, s42, s54
s_add_u32 s53, s43, s54
s_add_u32 s48, s48, 1
s_and_b32 s48, s48, 7
v_mfma_f32_32x32x16_bf16 v[128:143], v[32:35], v[48:51], v[128:143]
buffer_load_dwordx4 v3, s[20:23], s50 offen offset:0 lds
ds_read_b64_tr_b16 v[64:65], v12 offset:57344
ds_read_b64_tr_b16 v[66:67], v12 offset:58368
v_mfma_f32_32x32x16_bf16 v[144:159], v[32:35], v[52:55], v[144:159]
ds_read_b128 v[80:83], v10 offset:32768
ds_read_b64_tr_b16 v[68:69], v13 offset:57344
v_mfma_f32_32x32x16_bf16 v[160:175], v[36:39], v[48:51], v[160:175]
buffer_load_dwordx4 v5, s[20:23], s51 offen offset:1024 lds
ds_read_b64_tr_b16 v[70:71], v13 offset:58368
ds_read_b128 v[84:87], v10 offset:36864
v_mfma_f32_32x32x16_bf16 v[176:191], v[36:39], v[52:55], v[176:191]
ds_read_b64_tr_b16 v[72:73], v12 offset:61440
ds_read_b64_tr_b16 v[74:75], v12 offset:62464
v_mfma_f32_32x32x16_bf16 v[128:143], v[40:43], v[56:59], v[128:143]
buffer_load_dwordx4 v3, s[20:23], s52 offen offset:2048 lds
ds_read_b128 v[88:91], v11 offset:32768
ds_read_b64_tr_b16 v[76:77], v13 offset:61440
v_mfma_f32_32x32x16_bf16 v[144:159], v[40:43], v[60:63], v[144:159]
ds_read_b64_tr_b16 v[78:79], v13 offset:62464
ds_read_b128 v[92:95], v11 offset:36864
v_mfma_f32_32x32x16_bf16 v[160:175], v[44:47], v[56:59], v[160:175]
buffer_load_dwordx4 v5, s[20:23], s53 offen offset:3072 lds
v_mfma_f32_32x32x16_bf16 v[176:191], v[44:47], v[60:63], v[176:191]
s_waitcnt lgkmcnt(0)
s_waitcnt vmcnt(4)
s_barrier
v_add_u32 v16, 65536, v8
v_add_u32 v17, 65536, v9
s_add_u32 m0, s15, 32768
s_mul_i32 s54, s49, 229376
s_add_u32 s56, s44, s54
s_add_u32 s57, s45, s54
s_add_u32 s58, s46, s54
s_add_u32 s59, s47, s54
s_add_u32 s49, s49, 1
s_and_b32 s49, s49, 7
v_mfma_f32_32x32x16_bf16 v[128:143], v[64:67], v[80:83], v[128:143]
buffer_load_dwordx4 v4, s[24:27], s56 offen offset:0 lds
ds_read_b64_tr_b16 v[32:33], v12 offset:0
ds_read_b64_tr_b16 v[34:35], v12 offset:1024
v_mfma_f32_32x32x16_bf16 v[144:159], v[64:67], v[84:87], v[144:159]
ds_read_b128 v[48:51], v16 offset:0
ds_read_b64_tr_b16 v[36:37], v13 offset:0
v_mfma_f32_32x32x16_bf16 v[160:175], v[68:71], v[80:83], v[160:175]
buffer_load_dwordx4 v4, s[24:27], s57 offen offset:1024 lds
ds_read_b64_tr_b16 v[38:39], v13 offset:1024
ds_read_b128 v[52:55], v16 offset:4096
v_mfma_f32_32x32x16_bf16 v[176:191], v[68:71], v[84:87], v[176:191]
ds_read_b64_tr_b16 v[40:41], v12 offset:4096
ds_read_b64_tr_b16 v[42:43], v12 offset:5120
v_mfma_f32_32x32x16_bf16 v[128:143], v[72:75], v[88:91], v[128:143]
buffer_load_dwordx4 v4, s[24:27], s58 offen offset:2048 lds
ds_read_b128 v[56:59], v17 offset:0
ds_read_b64_tr_b16 v[44:45], v13 offset:4096
v_mfma_f32_32x32x16_bf16 v[144:159], v[72:75], v[92:95], v[144:159]
ds_read_b64_tr_b16 v[46:47], v13 offset:5120
ds_read_b128 v[60:63], v17 offset:4096
v_mfma_f32_32x32x16_bf16 v[160:175], v[76:79], v[88:91], v[160:175]
buffer_load_dwordx4 v4, s[24:27], s59 offen offset:3072 lds
v_mfma_f32_32x32x16_bf16 v[176:191], v[76:79], v[92:95], v[176:191]
s_waitcnt lgkmcnt(0)
v_add_u32 v16, 65536, v10
v_add_u32 v17, 65536, v11
s_add_u32 m0, s15, 49152
s_lshl_b32 s54, s48, 7
s_add_u32 s50, s40, s54
s_add_u32 s51, s41, s54
s_add_u32 s52, s42, s54
s_add_u32 s53, s43, s54
s_add_u32 s48, s48, 1
s_and_b32 s48, s48, 7
v_mfma_f32_32x32x16_bf16 v[128:143], v[32:35], v[48:51], v[128:143]
buffer_load_dwordx4 v3, s[20:23], s50 offen offset:0 lds
ds_read_b64_tr_b16 v[64:65], v12 offset:8192
ds_read_b64_tr_b16 v[66:67], v12 offset:9216
v_mfma_f32_32x32x16_bf16 v[144:159], v[32:35], v[52:55], v[144:159]
ds_read_b128 v[80:83], v16 offset:0
ds_read_b64_tr_b16 v[68:69], v13 offset:8192
v_mfma_f32_32x32x16_bf16 v[160:175], v[36:39], v[48:51], v[160:175]
buffer_load_dwordx4 v5, s[20:23], s51 offen offset:1024 lds
ds_read_b64_tr_b16 v[70:71], v13 offset:9216
ds_read_b128 v[84:87], v16 offset:4096
v_mfma_f32_32x32x16_bf16 v[176:191], v[36:39], v[52:55], v[176:191]
ds_read_b64_tr_b16 v[72:73], v12 offset:12288
ds_read_b64_tr_b16 v[74:75], v12 offset:13312
v_mfma_f32_32x32x16_bf16 v[128:143], v[40:43], v[56:59], v[128:143]
buffer_load_dwordx4 v3, s[20:23], s52 offen offset:2048 lds
ds_read_b128 v[88:91], v17 offset:0
ds_read_b64_tr_b16 v[76:77], v13 offset:12288
v_mfma_f32_32x32x16_bf16 v[144:159], v[40:43], v[60:63], v[144:159]
ds_read_b64_tr_b16 v[78:79], v13 offset:13312
ds_read_b128 v[92:95], v17 offset:4096
v_mfma_f32_32x32x16_bf16 v[160:175], v[44:47], v[56:59], v[160:175]
buffer_load_dwordx4 v5, s[20:23], s53 offen offset:3072 lds
v_mfma_f32_32x32x16_bf16 v[176:191], v[44:47], v[60:63], v[176:191]
s_setprio 1
s_waitcnt lgkmcnt(0)
s_waitcnt vmcnt(4)
s_barrier
s_add_u32 m0, s15, 65536
s_mul_i32 s54, s49, 229376
s_add_u32 s56, s44, s54
s_add_u32 s57, s45, s54
s_add_u32 s58, s46, s54
s_add_u32 s59, s47, s54
s_add_u32 s49, s49, 1
s_and_b32 s49, s49, 7
v_mfma_f32_32x32x16_bf16 v[128:143], v[64:67], v[80:83], v[128:143]
buffer_load_dwordx4 v4, s[24:27], s56 offen offset:0 lds
ds_read_b64_tr_b16 v[32:33], v12 offset:32768
ds_read_b64_tr_b16 v[34:35], v12 offset:33792
v_mfma_f32_32x32x16_bf16 v[144:159], v[64:67], v[84:87], v[144:159]
ds_read_b128 v[48:51], v8 offset:16384
ds_read_b64_tr_b16 v[36:37], v13 offset:32768
v_mfma_f32_32x32x16_bf16 v[160:175], v[68:71], v[80:83], v[160:175]
buffer_load_dwordx4 v4, s[24:27], s57 offen offset:1024 lds
ds_read_b64_tr_b16 v[38:39], v13 offset:33792
ds_read_b128 v[52:55], v8 offset:20480
v_mfma_f32_32x32x16_bf16 v[176:191], v[68:71], v[84:87], v[176:191]
ds_read_b64_tr_b16 v[40:41], v12 offset:36864
ds_read_b64_tr_b16 v[42:43], v12 offset:37888
v_mfma_f32_32x32x16_bf16 v[128:143], v[72:75], v[88:91], v[128:143]
buffer_load_dwordx4 v4, s[24:27], s58 offen offset:2048 lds
ds_read_b128 v[56:59], v9 offset:16384
ds_read_b64_tr_b16 v[44:45], v13 offset:36864
v_mfma_f32_32x32x16_bf16 v[144:159], v[72:75], v[92:95], v[144:159]
ds_read_b64_tr_b16 v[46:47], v13 offset:37888
ds_read_b128 v[60:63], v9 offset:20480
v_mfma_f32_32x32x16_bf16 v[160:175], v[76:79], v[88:91], v[160:175]
buffer_load_dwordx4 v4, s[24:27], s59 offen offset:3072 lds
v_mfma_f32_32x32x16_bf16 v[176:191], v[76:79], v[92:95], v[176:191]
s_waitcnt lgkmcnt(0)
s_add_u32 m0, s15, 0
s_lshl_b32 s54, s48, 7
s_add_u32 s50, s40, s54
s_add_u32 s51, s41, s54
s_add_u32 s52, s42, s54
s_add_u32 s53, s43, s54
s_add_u32 s48, s48, 1
s_and_b32 s48, s48, 7
v_mfma_f32_32x32x16_bf16 v[128:143], v[32:35], v[48:51], v[128:143]
buffer_load_dwordx4 v3, s[20:23], s50 offen offset:0 lds
ds_read_b64_tr_b16 v[64:65], v12 offset:40960
ds_read_b64_tr_b16 v[66:67], v12 offset:41984
v_mfma_f32_32x32x16_bf16 v[144:159], v[32:35], v[52:55], v[144:159]
ds_read_b128 v[80:83], v10 offset:16384
ds_read_b64_tr_b16 v[68:69], v13 offset:40960
v_mfma_f32_32x32x16_bf16 v[160:175], v[36:39], v[48:51], v[160:175]
buffer_load_dwordx4 v5, s[20:23], s51 offen offset:1024 lds
ds_read_b64_tr_b16 v[70:71], v13 offset:41984
ds_read_b128 v[84:87], v10 offset:20480
v_mfma_f32_32x32x16_bf16 v[176:191], v[36:39], v[52:55], v[176:191]
ds_read_b64_tr_b16 v[72:73], v12 offset:45056
ds_read_b64_tr_b16 v[74:75], v12 offset:46080
v_mfma_f32_32x32x16_bf16 v[128:143], v[40:43], v[56:59], v[128:143]
buffer_load_dwordx4 v3, s[20:23], s52 offen offset:2048 lds
ds_read_b128 v[88:91], v11 offset:16384
ds_read_b64_tr_b16 v[76:77], v13 offset:45056
v_mfma_f32_32x32x16_bf16 v[144:159], v[40:43], v[60:63], v[144:159]
ds_read_b64_tr_b16 v[78:79], v13 offset:46080
ds_read_b128 v[92:95], v11 offset:20480
v_mfma_f32_32x32x16_bf16 v[160:175], v[44:47], v[56:59], v[160:175]
buffer_load_dwordx4 v5, s[20:23], s53 offen offset:3072 lds
v_mfma_f32_32x32x16_bf16 v[176:191], v[44:47], v[60:63], v[176:191]
s_waitcnt lgkmcnt(0)
s_waitcnt vmcnt(4)
s_barrier
v_add_u32 v18, 65536, v12
v_add_u32 v19, 65536, v13
s_add_u32 m0, s15, 16384
s_mul_i32 s54, s49, 229376
s_add_u32 s56, s44, s54
s_add_u32 s57, s45, s54
s_add_u32 s58, s46, s54
s_add_u32 s59, s47, s54
s_add_u32 s49, s49, 1
s_and_b32 s49, s49, 7
v_mfma_f32_32x32x16_bf16 v[128:143], v[64:67], v[80:83], v[128:143]
buffer_load_dwordx4 v4, s[24:27], s56 offen offset:0 lds
ds_read_b64_tr_b16 v[32:33], v18 offset:0
ds_read_b64_tr_b16 v[34:35], v18 offset:1024
v_mfma_f32_32x32x16_bf16 v[144:159], v[64:67], v[84:87], v[144:159]
ds_read_b128 v[48:51], v8 offset:49152
ds_read_b64_tr_b16 v[36:37], v19 offset:0
v_mfma_f32_32x32x16_bf16 v[160:175], v[68:71], v[80:83], v[160:175]
buffer_load_dwordx4 v4, s[24:27], s57 offen offset:1024 lds
ds_read_b64_tr_b16 v[38:39], v19 offset:1024
ds_read_b128 v[52:55], v8 offset:53248
v_mfma_f32_32x32x16_bf16 v[176:191], v[68:71], v[84:87], v[176:191]
ds_read_b64_tr_b16 v[40:41], v18 offset:4096
ds_read_b64_tr_b16 v[42:43], v18 offset:5120
v_mfma_f32_32x32x16_bf16 v[128:143], v[72:75], v[88:91], v[128:143]
buffer_load_dwordx4 v4, s[24:27], s58 offen offset:2048 lds
ds_read_b128 v[56:59], v9 offset:49152
ds_read_b64_tr_b16 v[44:45], v19 offset:4096
v_mfma_f32_32x32x16_bf16 v[144:159], v[72:75], v[92:95], v[144:159]
ds_read_b64_tr_b16 v[46:47], v19 offset:5120
ds_read_b128 v[60:63], v9 offset:53248
v_mfma_f32_32x32x16_bf16 v[160:175], v[76:79], v[88:91], v[160:175]
buffer_load_dwordx4 v4, s[24:27], s59 offen offset:3072 lds
v_mfma_f32_32x32x16_bf16 v[176:191], v[76:79], v[92:95], v[176:191]
s_waitcnt lgkmcnt(0)
v_add_u32 v18, 73728, v12
v_add_u32 v19, 73728, v13
s_add_u32 m0, s15, 32768
s_lshl_b32 s54, s48, 7
s_add_u32 s50, s40, s54
s_add_u32 s51, s41, s54
s_add_u32 s52, s42, s54
s_add_u32 s53, s43, s54
s_add_u32 s48, s48, 1
s_and_b32 s48, s48, 7
v_mfma_f32_32x32x16_bf16 v[128:143], v[32:35], v[48:51], v[128:143]
buffer_load_dwordx4 v3, s[20:23], s50 offen offset:0 lds
ds_read_b64_tr_b16 v[64:65], v18 offset:0
ds_read_b64_tr_b16 v[66:67], v18 offset:1024
v_mfma_f32_32x32x16_bf16 v[144:159], v[32:35], v[52:55], v[144:159]
ds_read_b128 v[80:83], v10 offset:49152
ds_read_b64_tr_b16 v[68:69], v19 offset:0
v_mfma_f32_32x32x16_bf16 v[160:175], v[36:39], v[48:51], v[160:175]
buffer_load_dwordx4 v5, s[20:23], s51 offen offset:1024 lds
ds_read_b64_tr_b16 v[70:71], v19 offset:1024
ds_read_b128 v[84:87], v10 offset:53248
v_mfma_f32_32x32x16_bf16 v[176:191], v[36:39], v[52:55], v[176:191]
ds_read_b64_tr_b16 v[72:73], v18 offset:4096
ds_read_b64_tr_b16 v[74:75], v18 offset:5120
v_mfma_f32_32x32x16_bf16 v[128:143], v[40:43], v[56:59], v[128:143]
buffer_load_dwordx4 v3, s[20:23], s52 offen offset:2048 lds
ds_read_b128 v[88:91], v11 offset:49152
ds_read_b64_tr_b16 v[76:77], v19 offset:4096
v_mfma_f32_32x32x16_bf16 v[144:159], v[40:43], v[60:63], v[144:159]
ds_read_b64_tr_b16 v[78:79], v19 offset:5120
ds_read_b128 v[92:95], v11 offset:53248
v_mfma_f32_32x32x16_bf16 v[160:175], v[44:47], v[56:59], v[160:175]
buffer_load_dwordx4 v5, s[20:23], s53 offen offset:3072 lds
v_mfma_f32_32x32x16_bf16 v[176:191], v[44:47], v[60:63], v[176:191]
s_waitcnt lgkmcnt(0)
s_waitcnt vmcnt(4)
s_barrier
s_add_u32 m0, s15, 49152
s_mul_i32 s54, s49, 229376
s_add_u32 s56, s44, s54
s_add_u32 s57, s45, s54
s_add_u32 s58, s46, s54
s_add_u32 s59, s47, s54
s_add_u32 s49, s49, 1
s_and_b32 s49, s49, 7
v_mfma_f32_32x32x16_bf16 v[128:143], v[64:67], v[80:83], v[128:143]
buffer_load_dwordx4 v4, s[24:27], s56 offen offset:0 lds
ds_read_b64_tr_b16 v[32:33], v12 offset:16384
ds_read_b64_tr_b16 v[34:35], v12 offset:17408
v_mfma_f32_32x32x16_bf16 v[144:159], v[64:67], v[84:87], v[144:159]
ds_read_b128 v[48:51], v8 offset:0
ds_read_b64_tr_b16 v[36:37], v13 offset:16384
v_mfma_f32_32x32x16_bf16 v[160:175], v[68:71], v[80:83], v[160:175]
buffer_load_dwordx4 v4, s[24:27], s57 offen offset:1024 lds
ds_read_b64_tr_b16 v[38:39], v13 offset:17408
ds_read_b128 v[52:55], v8 offset:4096
v_mfma_f32_32x32x16_bf16 v[176:191], v[68:71], v[84:87], v[176:191]
ds_read_b64_tr_b16 v[40:41], v12 offset:20480
ds_read_b64_tr_b16 v[42:43], v12 offset:21504
v_mfma_f32_32x32x16_bf16 v[128:143], v[72:75], v[88:91], v[128:143]
buffer_load_dwordx4 v4, s[24:27], s58 offen offset:2048 lds
ds_read_b128 v[56:59], v9 offset:0
ds_read_b64_tr_b16 v[44:45], v13 offset:20480
v_mfma_f32_32x32x16_bf16 v[144:159], v[72:75], v[92:95], v[144:159]
ds_read_b64_tr_b16 v[46:47], v13 offset:21504
ds_read_b128 v[60:63], v9 offset:4096
v_mfma_f32_32x32x16_bf16 v[160:175], v[76:79], v[88:91], v[160:175]
buffer_load_dwordx4 v4, s[24:27], s59 offen offset:3072 lds
v_mfma_f32_32x32x16_bf16 v[176:191], v[76:79], v[92:95], v[176:191]
s_waitcnt lgkmcnt(0)
s_add_u32 m0, s15, 65536
s_lshl_b32 s54, s48, 7
s_add_u32 s50, s40, s54
s_add_u32 s51, s41, s54
s_add_u32 s52, s42, s54
s_add_u32 s53, s43, s54
s_add_u32 s48, s48, 1
s_and_b32 s48, s48, 7
v_mfma_f32_32x32x16_bf16 v[128:143], v[32:35], v[48:51], v[128:143]
buffer_load_dwordx4 v3, s[20:23], s50 offen offset:0 lds
ds_read_b64_tr_b16 v[64:65], v12 offset:24576
ds_read_b64_tr_b16 v[66:67], v12 offset:25600
v_mfma_f32_32x32x16_bf16 v[144:159], v[32:35], v[52:55], v[144:159]
ds_read_b128 v[80:83], v10 offset:0
ds_read_b64_tr_b16 v[68:69], v13 offset:24576
v_mfma_f32_32x32x16_bf16 v[160:175], v[36:39], v[48:51], v[160:175]
buffer_load_dwordx4 v5, s[20:23], s51 offen offset:1024 lds
ds_read_b64_tr_b16 v[70:71], v13 offset:25600
ds_read_b128 v[84:87], v10 offset:4096
v_mfma_f32_32x32x16_bf16 v[176:191], v[36:39], v[52:55], v[176:191]
ds_read_b64_tr_b16 v[72:73], v12 offset:28672
ds_read_b64_tr_b16 v[74:75], v12 offset:29696
v_mfma_f32_32x32x16_bf16 v[128:143], v[40:43], v[56:59], v[128:143]
buffer_load_dwordx4 v3, s[20:23], s52 offen offset:2048 lds
ds_read_b128 v[88:91], v11 offset:0
ds_read_b64_tr_b16 v[76:77], v13 offset:28672
v_mfma_f32_32x32x16_bf16 v[144:159], v[40:43], v[60:63], v[144:159]
ds_read_b64_tr_b16 v[78:79], v13 offset:29696
ds_read_b128 v[92:95], v11 offset:4096
v_mfma_f32_32x32x16_bf16 v[160:175], v[44:47], v[56:59], v[160:175]
buffer_load_dwordx4 v5, s[20:23], s53 offen offset:3072 lds
v_mfma_f32_32x32x16_bf16 v[176:191], v[44:47], v[60:63], v[176:191]
s_waitcnt lgkmcnt(0)
s_waitcnt vmcnt(4)
s_barrier
s_add_u32 m0, s15, 0
s_mul_i32 s54, s49, 229376
s_add_u32 s56, s44, s54
s_add_u32 s57, s45, s54
s_add_u32 s58, s46, s54
s_add_u32 s59, s47, s54
s_add_u32 s49, s49, 1
s_and_b32 s49, s49, 7
v_mfma_f32_32x32x16_bf16 v[128:143], v[64:67], v[80:83], v[128:143]
buffer_load_dwordx4 v4, s[24:27], s56 offen offset:0 lds
ds_read_b64_tr_b16 v[32:33], v12 offset:49152
ds_read_b64_tr_b16 v[34:35], v12 offset:50176
v_mfma_f32_32x32x16_bf16 v[144:159], v[64:67], v[84:87], v[144:159]
ds_read_b128 v[48:51], v8 offset:32768
ds_read_b64_tr_b16 v[36:37], v13 offset:49152
v_mfma_f32_32x32x16_bf16 v[160:175], v[68:71], v[80:83], v[160:175]
buffer_load_dwordx4 v4, s[24:27], s57 offen offset:1024 lds
ds_read_b64_tr_b16 v[38:39], v13 offset:50176
ds_read_b128 v[52:55], v8 offset:36864
v_mfma_f32_32x32x16_bf16 v[176:191], v[68:71], v[84:87], v[176:191]
ds_read_b64_tr_b16 v[40:41], v12 offset:53248
ds_read_b64_tr_b16 v[42:43], v12 offset:54272
v_mfma_f32_32x32x16_bf16 v[128:143], v[72:75], v[88:91], v[128:143]
buffer_load_dwordx4 v4, s[24:27], s58 offen offset:2048 lds
ds_read_b128 v[56:59], v9 offset:32768
ds_read_b64_tr_b16 v[44:45], v13 offset:53248
v_mfma_f32_32x32x16_bf16 v[144:159], v[72:75], v[92:95], v[144:159]
ds_read_b64_tr_b16 v[46:47], v13 offset:54272
ds_read_b128 v[60:63], v9 offset:36864
v_mfma_f32_32x32x16_bf16 v[160:175], v[76:79], v[88:91], v[160:175]
buffer_load_dwordx4 v4, s[24:27], s59 offen offset:3072 lds
v_mfma_f32_32x32x16_bf16 v[176:191], v[76:79], v[92:95], v[176:191]
s_waitcnt lgkmcnt(0)
v_mfma_f32_32x32x16_bf16 v[128:143], v[32:35], v[48:51], v[128:143]
ds_read_b64_tr_b16 v[64:65], v12 offset:57344
ds_read_b64_tr_b16 v[66:67], v12 offset:58368
v_mfma_f32_32x32x16_bf16 v[144:159], v[32:35], v[52:55], v[144:159]
ds_read_b128 v[80:83], v10 offset:32768
ds_read_b64_tr_b16 v[68:69], v13 offset:57344
v_mfma_f32_32x32x16_bf16 v[160:175], v[36:39], v[48:51], v[160:175]
ds_read_b64_tr_b16 v[70:71], v13 offset:58368
ds_read_b128 v[84:87], v10 offset:36864
v_mfma_f32_32x32x16_bf16 v[176:191], v[36:39], v[52:55], v[176:191]
ds_read_b64_tr_b16 v[72:73], v12 offset:61440
ds_read_b64_tr_b16 v[74:75], v12 offset:62464
v_mfma_f32_32x32x16_bf16 v[128:143], v[40:43], v[56:59], v[128:143]
ds_read_b128 v[88:91], v11 offset:32768
ds_read_b64_tr_b16 v[76:77], v13 offset:61440
v_mfma_f32_32x32x16_bf16 v[144:159], v[40:43], v[60:63], v[144:159]
ds_read_b64_tr_b16 v[78:79], v13 offset:62464
ds_read_b128 v[92:95], v11 offset:36864
v_mfma_f32_32x32x16_bf16 v[160:175], v[44:47], v[56:59], v[160:175]
v_mfma_f32_32x32x16_bf16 v[176:191], v[44:47], v[60:63], v[176:191]
s_waitcnt lgkmcnt(0)
s_waitcnt vmcnt(0)
s_barrier
v_add_u32 v16, 65536, v8
v_add_u32 v17, 65536, v9
v_mfma_f32_32x32x16_bf16 v[128:143], v[64:67], v[80:83], v[128:143]
ds_read_b64_tr_b16 v[32:33], v12 offset:0
ds_read_b64_tr_b16 v[34:35], v12 offset:1024
v_mfma_f32_32x32x16_bf16 v[144:159], v[64:67], v[84:87], v[144:159]
ds_read_b128 v[48:51], v16 offset:0
ds_read_b64_tr_b16 v[36:37], v13 offset:0
v_mfma_f32_32x32x16_bf16 v[160:175], v[68:71], v[80:83], v[160:175]
ds_read_b64_tr_b16 v[38:39], v13 offset:1024
ds_read_b128 v[52:55], v16 offset:4096
v_mfma_f32_32x32x16_bf16 v[176:191], v[68:71], v[84:87], v[176:191]
ds_read_b64_tr_b16 v[40:41], v12 offset:4096
ds_read_b64_tr_b16 v[42:43], v12 offset:5120
v_mfma_f32_32x32x16_bf16 v[128:143], v[72:75], v[88:91], v[128:143]
ds_read_b128 v[56:59], v17 offset:0
ds_read_b64_tr_b16 v[44:45], v13 offset:4096
v_mfma_f32_32x32x16_bf16 v[144:159], v[72:75], v[92:95], v[144:159]
ds_read_b64_tr_b16 v[46:47], v13 offset:5120
ds_read_b128 v[60:63], v17 offset:4096
v_mfma_f32_32x32x16_bf16 v[160:175], v[76:79], v[88:91], v[160:175]
v_mfma_f32_32x32x16_bf16 v[176:191], v[76:79], v[92:95], v[176:191]
s_waitcnt lgkmcnt(0)
v_add_u32 v16, 65536, v10
v_add_u32 v17, 65536, v11
v_mfma_f32_32x32x16_bf16 v[128:143], v[32:35], v[48:51], v[128:143]
ds_read_b64_tr_b16 v[64:65], v12 offset:8192
ds_read_b64_tr_b16 v[66:67], v12 offset:9216
v_mfma_f32_32x32x16_bf16 v[144:159], v[32:35], v[52:55], v[144:159]
ds_read_b128 v[80:83], v16 offset:0
ds_read_b64_tr_b16 v[68:69], v13 offset:8192
v_mfma_f32_32x32x16_bf16 v[160:175], v[36:39], v[48:51], v[160:175]
ds_read_b64_tr_b16 v[70:71], v13 offset:9216
ds_read_b128 v[84:87], v16 offset:4096
v_mfma_f32_32x32x16_bf16 v[176:191], v[36:39], v[52:55], v[176:191]
ds_read_b64_tr_b16 v[72:73], v12 offset:12288
ds_read_b64_tr_b16 v[74:75], v12 offset:13312
v_mfma_f32_32x32x16_bf16 v[128:143], v[40:43], v[56:59], v[128:143]
ds_read_b128 v[88:91], v17 offset:0
ds_read_b64_tr_b16 v[76:77], v13 offset:12288
v_mfma_f32_32x32x16_bf16 v[144:159], v[40:43], v[60:63], v[144:159]
ds_read_b64_tr_b16 v[78:79], v13 offset:13312
ds_read_b128 v[92:95], v17 offset:4096
v_mfma_f32_32x32x16_bf16 v[160:175], v[44:47], v[56:59], v[160:175]
v_mfma_f32_32x32x16_bf16 v[176:191], v[44:47], v[60:63], v[176:191]
s_waitcnt lgkmcnt(0)
v_mfma_f32_32x32x16_bf16 v[128:143], v[64:67], v[80:83], v[128:143]
v_mfma_f32_32x32x16_bf16 v[144:159], v[64:67], v[84:87], v[144:159]
v_mfma_f32_32x32x16_bf16 v[160:175], v[68:71], v[80:83], v[160:175]
v_mfma_f32_32x32x16_bf16 v[176:191], v[68:71], v[84:87], v[176:191]
v_mfma_f32_32x32x16_bf16 v[128:143], v[72:75], v[88:91], v[128:143]
v_mfma_f32_32x32x16_bf16 v[144:159], v[72:75], v[92:95], v[144:159]
v_mfma_f32_32x32x16_bf16 v[160:175], v[76:79], v[88:91], v[160:175]
v_mfma_f32_32x32x16_bf16 v[176:191], v[76:79], v[92:95], v[176:191]
s_setprio 0
s_nop 7
s_nop 7
s_nop 7
s_mov_b32 s30, 0xbfb8aa3b
s_mov_b32 s31, 0xffff0000
s_lshl_b32 s32, s10, 1
s_add_u32 s32, s32, s19
s_mul_i32 s32, s32, 56
s_lshl_b32 s33, s12, 2
s_add_u32 s32, s32, s33
s_lshl_b32 s33, s28, 1
s_add_u32 s32, s32, s33
s_lshl_b32 s32, s32, 12
s_add_u32 s36, s4, s32
s_addc_u32 s37, s5, 0
s_and_b32 s37, s37, 0xffff
s_mov_b32 s38, 8192
s_mov_b32 s39, 0x20000
s_mov_b32 s34, 4096
v_cvt_pk_bf16_f32 v128, 0, v128
v_cvt_pk_bf16_f32 v129, 0, v129
v_cvt_pk_bf16_f32 v130, 0, v130
v_cvt_pk_bf16_f32 v131, 0, v131
v_cvt_pk_bf16_f32 v132, 0, v132
v_cvt_pk_bf16_f32 v133, 0, v133
v_cvt_pk_bf16_f32 v134, 0, v134
v_cvt_pk_bf16_f32 v135, 0, v135
v_mul_f32 v16, s30, v128
v_mul_f32 v17, s30, v129
v_mul_f32 v18, s30, v130
v_mul_f32 v19, s30, v131
v_mul_f32 v20, s30, v132
v_mul_f32 v21, s30, v133
v_mul_f32 v22, s30, v134
v_mul_f32 v23, s30, v135
v_exp_f32 v16, v16
v_exp_f32 v17, v17
v_exp_f32 v18, v18
v_exp_f32 v19, v19
v_exp_f32 v20, v20
v_exp_f32 v21, v21
v_exp_f32 v22, v22
v_exp_f32 v23, v23
v_add_f32 v16, 1.0, v16
v_add_f32 v17, 1.0, v17
v_add_f32 v18, 1.0, v18
v_add_f32 v19, 1.0, v19
v_add_f32 v20, 1.0, v20
v_add_f32 v21, 1.0, v21
v_add_f32 v22, 1.0, v22
v_add_f32 v23, 1.0, v23
v_rcp_f32 v16, v16
v_rcp_f32 v17, v17
v_rcp_f32 v18, v18
v_rcp_f32 v19, v19
v_rcp_f32 v20, v20
v_rcp_f32 v21, v21
v_rcp_f32 v22, v22
v_rcp_f32 v23, v23
v_mul_f32 v16, v16, v128
v_mul_f32 v17, v17, v129
v_mul_f32 v18, v18, v130
v_mul_f32 v19, v19, v131
v_mul_f32 v20, v20, v132
v_mul_f32 v21, v21, v133
v_mul_f32 v22, v22, v134
v_mul_f32 v23, v23, v135
v_cvt_pk_bf16_f32 v32, v16, v17
v_cvt_pk_bf16_f32 v33, v18, v19
v_cvt_pk_bf16_f32 v34, v20, v21
v_cvt_pk_bf16_f32 v35, v22, v23
buffer_store_dwordx4 v[32:35], v14, s[36:39], 0 offen offset:0 sc1
v_cvt_pk_bf16_f32 v136, 0, v136
v_cvt_pk_bf16_f32 v137, 0, v137
v_cvt_pk_bf16_f32 v138, 0, v138
v_cvt_pk_bf16_f32 v139, 0, v139
v_cvt_pk_bf16_f32 v140, 0, v140
v_cvt_pk_bf16_f32 v141, 0, v141
v_cvt_pk_bf16_f32 v142, 0, v142
v_cvt_pk_bf16_f32 v143, 0, v143
v_mul_f32 v16, s30, v136
v_mul_f32 v17, s30, v137
v_mul_f32 v18, s30, v138
v_mul_f32 v19, s30, v139
v_mul_f32 v20, s30, v140
v_mul_f32 v21, s30, v141
v_mul_f32 v22, s30, v142
v_mul_f32 v23, s30, v143
v_exp_f32 v16, v16
v_exp_f32 v17, v17
v_exp_f32 v18, v18
v_exp_f32 v19, v19
v_exp_f32 v20, v20
v_exp_f32 v21, v21
v_exp_f32 v22, v22
v_exp_f32 v23, v23
v_add_f32 v16, 1.0, v16
v_add_f32 v17, 1.0, v17
v_add_f32 v18, 1.0, v18
v_add_f32 v19, 1.0, v19
v_add_f32 v20, 1.0, v20
v_add_f32 v21, 1.0, v21
v_add_f32 v22, 1.0, v22
v_add_f32 v23, 1.0, v23
v_rcp_f32 v16, v16
v_rcp_f32 v17, v17
v_rcp_f32 v18, v18
v_rcp_f32 v19, v19
v_rcp_f32 v20, v20
v_rcp_f32 v21, v21
v_rcp_f32 v22, v22
v_rcp_f32 v23, v23
v_mul_f32 v16, v16, v136
v_mul_f32 v17, v17, v137
v_mul_f32 v18, v18, v138
v_mul_f32 v19, v19, v139
v_mul_f32 v20, v20, v140
v_mul_f32 v21, v21, v141
v_mul_f32 v22, v22, v142
v_mul_f32 v23, v23, v143
v_cvt_pk_bf16_f32 v36, v16, v17
v_cvt_pk_bf16_f32 v37, v18, v19
v_cvt_pk_bf16_f32 v38, v20, v21
v_cvt_pk_bf16_f32 v39, v22, v23
buffer_store_dwordx4 v[36:39], v14, s[36:39], 0 offen offset:512 sc1
v_cvt_pk_bf16_f32 v144, 0, v144
v_cvt_pk_bf16_f32 v145, 0, v145
v_cvt_pk_bf16_f32 v146, 0, v146
v_cvt_pk_bf16_f32 v147, 0, v147
v_cvt_pk_bf16_f32 v148, 0, v148
v_cvt_pk_bf16_f32 v149, 0, v149
v_cvt_pk_bf16_f32 v150, 0, v150
v_cvt_pk_bf16_f32 v151, 0, v151
v_mul_f32 v16, s30, v144
v_mul_f32 v17, s30, v145
v_mul_f32 v18, s30, v146
v_mul_f32 v19, s30, v147
v_mul_f32 v20, s30, v148
v_mul_f32 v21, s30, v149
v_mul_f32 v22, s30, v150
v_mul_f32 v23, s30, v151
v_exp_f32 v16, v16
v_exp_f32 v17, v17
v_exp_f32 v18, v18
v_exp_f32 v19, v19
v_exp_f32 v20, v20
v_exp_f32 v21, v21
v_exp_f32 v22, v22
v_exp_f32 v23, v23
v_add_f32 v16, 1.0, v16
v_add_f32 v17, 1.0, v17
v_add_f32 v18, 1.0, v18
v_add_f32 v19, 1.0, v19
v_add_f32 v20, 1.0, v20
v_add_f32 v21, 1.0, v21
v_add_f32 v22, 1.0, v22
v_add_f32 v23, 1.0, v23
v_rcp_f32 v16, v16
v_rcp_f32 v17, v17
v_rcp_f32 v18, v18
v_rcp_f32 v19, v19
v_rcp_f32 v20, v20
v_rcp_f32 v21, v21
v_rcp_f32 v22, v22
v_rcp_f32 v23, v23
v_mul_f32 v16, v16, v144
v_mul_f32 v17, v17, v145
v_mul_f32 v18, v18, v146
v_mul_f32 v19, v19, v147
v_mul_f32 v20, v20, v148
v_mul_f32 v21, v21, v149
v_mul_f32 v22, v22, v150
v_mul_f32 v23, v23, v151
v_cvt_pk_bf16_f32 v40, v16, v17
v_cvt_pk_bf16_f32 v41, v18, v19
v_cvt_pk_bf16_f32 v42, v20, v21
v_cvt_pk_bf16_f32 v43, v22, v23
buffer_store_dwordx4 v[40:43], v14, s[36:39], 0 offen offset:2048 sc1
v_cvt_pk_bf16_f32 v152, 0, v152
v_cvt_pk_bf16_f32 v153, 0, v153
v_cvt_pk_bf16_f32 v154, 0, v154
v_cvt_pk_bf16_f32 v155, 0, v155
v_cvt_pk_bf16_f32 v156, 0, v156
v_cvt_pk_bf16_f32 v157, 0, v157
v_cvt_pk_bf16_f32 v158, 0, v158
v_cvt_pk_bf16_f32 v159, 0, v159
v_mul_f32 v16, s30, v152
v_mul_f32 v17, s30, v153
v_mul_f32 v18, s30, v154
v_mul_f32 v19, s30, v155
v_mul_f32 v20, s30, v156
v_mul_f32 v21, s30, v157
v_mul_f32 v22, s30, v158
v_mul_f32 v23, s30, v159
v_exp_f32 v16, v16
v_exp_f32 v17, v17
v_exp_f32 v18, v18
v_exp_f32 v19, v19
v_exp_f32 v20, v20
v_exp_f32 v21, v21
v_exp_f32 v22, v22
v_exp_f32 v23, v23
v_add_f32 v16, 1.0, v16
v_add_f32 v17, 1.0, v17
v_add_f32 v18, 1.0, v18
v_add_f32 v19, 1.0, v19
v_add_f32 v20, 1.0, v20
v_add_f32 v21, 1.0, v21
v_add_f32 v22, 1.0, v22
v_add_f32 v23, 1.0, v23
v_rcp_f32 v16, v16
v_rcp_f32 v17, v17
v_rcp_f32 v18, v18
v_rcp_f32 v19, v19
v_rcp_f32 v20, v20
v_rcp_f32 v21, v21
v_rcp_f32 v22, v22
v_rcp_f32 v23, v23
v_mul_f32 v16, v16, v152
v_mul_f32 v17, v17, v153
v_mul_f32 v18, v18, v154
v_mul_f32 v19, v19, v155
v_mul_f32 v20, v20, v156
v_mul_f32 v21, v21, v157
v_mul_f32 v22, v22, v158
v_mul_f32 v23, v23, v159
v_cvt_pk_bf16_f32 v44, v16, v17
v_cvt_pk_bf16_f32 v45, v18, v19
v_cvt_pk_bf16_f32 v46, v20, v21
v_cvt_pk_bf16_f32 v47, v22, v23
buffer_store_dwordx4 v[44:47], v14, s[36:39], 0 offen offset:2560 sc1
v_cvt_pk_bf16_f32 v160, 0, v160
v_cvt_pk_bf16_f32 v161, 0, v161
v_cvt_pk_bf16_f32 v162, 0, v162
v_cvt_pk_bf16_f32 v163, 0, v163
v_cvt_pk_bf16_f32 v164, 0, v164
v_cvt_pk_bf16_f32 v165, 0, v165
v_cvt_pk_bf16_f32 v166, 0, v166
v_cvt_pk_bf16_f32 v167, 0, v167
v_mul_f32 v16, s30, v160
v_mul_f32 v17, s30, v161
v_mul_f32 v18, s30, v162
v_mul_f32 v19, s30, v163
v_mul_f32 v20, s30, v164
v_mul_f32 v21, s30, v165
v_mul_f32 v22, s30, v166
v_mul_f32 v23, s30, v167
v_exp_f32 v16, v16
v_exp_f32 v17, v17
v_exp_f32 v18, v18
v_exp_f32 v19, v19
v_exp_f32 v20, v20
v_exp_f32 v21, v21
v_exp_f32 v22, v22
v_exp_f32 v23, v23
v_add_f32 v16, 1.0, v16
v_add_f32 v17, 1.0, v17
v_add_f32 v18, 1.0, v18
v_add_f32 v19, 1.0, v19
v_add_f32 v20, 1.0, v20
v_add_f32 v21, 1.0, v21
v_add_f32 v22, 1.0, v22
v_add_f32 v23, 1.0, v23
v_rcp_f32 v16, v16
v_rcp_f32 v17, v17
v_rcp_f32 v18, v18
v_rcp_f32 v19, v19
v_rcp_f32 v20, v20
v_rcp_f32 v21, v21
v_rcp_f32 v22, v22
v_rcp_f32 v23, v23
v_mul_f32 v16, v16, v160
v_mul_f32 v17, v17, v161
v_mul_f32 v18, v18, v162
v_mul_f32 v19, v19, v163
v_mul_f32 v20, v20, v164
v_mul_f32 v21, v21, v165
v_mul_f32 v22, v22, v166
v_mul_f32 v23, v23, v167
v_cvt_pk_bf16_f32 v48, v16, v17
v_cvt_pk_bf16_f32 v49, v18, v19
v_cvt_pk_bf16_f32 v50, v20, v21
v_cvt_pk_bf16_f32 v51, v22, v23
buffer_store_dwordx4 v[48:51], v14, s[36:39], s34 offen offset:0 sc1
v_cvt_pk_bf16_f32 v168, 0, v168
v_cvt_pk_bf16_f32 v169, 0, v169
v_cvt_pk_bf16_f32 v170, 0, v170
v_cvt_pk_bf16_f32 v171, 0, v171
v_cvt_pk_bf16_f32 v172, 0, v172
v_cvt_pk_bf16_f32 v173, 0, v173
v_cvt_pk_bf16_f32 v174, 0, v174
v_cvt_pk_bf16_f32 v175, 0, v175
v_mul_f32 v16, s30, v168
v_mul_f32 v17, s30, v169
v_mul_f32 v18, s30, v170
v_mul_f32 v19, s30, v171
v_mul_f32 v20, s30, v172
v_mul_f32 v21, s30, v173
v_mul_f32 v22, s30, v174
v_mul_f32 v23, s30, v175
v_exp_f32 v16, v16
v_exp_f32 v17, v17
v_exp_f32 v18, v18
v_exp_f32 v19, v19
v_exp_f32 v20, v20
v_exp_f32 v21, v21
v_exp_f32 v22, v22
v_exp_f32 v23, v23
v_add_f32 v16, 1.0, v16
v_add_f32 v17, 1.0, v17
v_add_f32 v18, 1.0, v18
v_add_f32 v19, 1.0, v19
v_add_f32 v20, 1.0, v20
v_add_f32 v21, 1.0, v21
v_add_f32 v22, 1.0, v22
v_add_f32 v23, 1.0, v23
v_rcp_f32 v16, v16
v_rcp_f32 v17, v17
v_rcp_f32 v18, v18
v_rcp_f32 v19, v19
v_rcp_f32 v20, v20
v_rcp_f32 v21, v21
v_rcp_f32 v22, v22
v_rcp_f32 v23, v23
v_mul_f32 v16, v16, v168
v_mul_f32 v17, v17, v169
v_mul_f32 v18, v18, v170
v_mul_f32 v19, v19, v171
v_mul_f32 v20, v20, v172
v_mul_f32 v21, v21, v173
v_mul_f32 v22, v22, v174
v_mul_f32 v23, v23, v175
v_cvt_pk_bf16_f32 v52, v16, v17
v_cvt_pk_bf16_f32 v53, v18, v19
v_cvt_pk_bf16_f32 v54, v20, v21
v_cvt_pk_bf16_f32 v55, v22, v23
buffer_store_dwordx4 v[52:55], v14, s[36:39], s34 offen offset:512 sc1
v_cvt_pk_bf16_f32 v176, 0, v176
v_cvt_pk_bf16_f32 v177, 0, v177
v_cvt_pk_bf16_f32 v178, 0, v178
v_cvt_pk_bf16_f32 v179, 0, v179
v_cvt_pk_bf16_f32 v180, 0, v180
v_cvt_pk_bf16_f32 v181, 0, v181
v_cvt_pk_bf16_f32 v182, 0, v182
v_cvt_pk_bf16_f32 v183, 0, v183
v_mul_f32 v16, s30, v176
v_mul_f32 v17, s30, v177
v_mul_f32 v18, s30, v178
v_mul_f32 v19, s30, v179
v_mul_f32 v20, s30, v180
v_mul_f32 v21, s30, v181
v_mul_f32 v22, s30, v182
v_mul_f32 v23, s30, v183
v_exp_f32 v16, v16
v_exp_f32 v17, v17
v_exp_f32 v18, v18
v_exp_f32 v19, v19
v_exp_f32 v20, v20
v_exp_f32 v21, v21
v_exp_f32 v22, v22
v_exp_f32 v23, v23
v_add_f32 v16, 1.0, v16
v_add_f32 v17, 1.0, v17
v_add_f32 v18, 1.0, v18
v_add_f32 v19, 1.0, v19
v_add_f32 v20, 1.0, v20
v_add_f32 v21, 1.0, v21
v_add_f32 v22, 1.0, v22
v_add_f32 v23, 1.0, v23
v_rcp_f32 v16, v16
v_rcp_f32 v17, v17
v_rcp_f32 v18, v18
v_rcp_f32 v19, v19
v_rcp_f32 v20, v20
v_rcp_f32 v21, v21
v_rcp_f32 v22, v22
v_rcp_f32 v23, v23
v_mul_f32 v16, v16, v176
v_mul_f32 v17, v17, v177
v_mul_f32 v18, v18, v178
v_mul_f32 v19, v19, v179
v_mul_f32 v20, v20, v180
v_mul_f32 v21, v21, v181
v_mul_f32 v22, v22, v182
v_mul_f32 v23, v23, v183
v_cvt_pk_bf16_f32 v56, v16, v17
v_cvt_pk_bf16_f32 v57, v18, v19
v_cvt_pk_bf16_f32 v58, v20, v21
v_cvt_pk_bf16_f32 v59, v22, v23
buffer_store_dwordx4 v[56:59], v14, s[36:39], s34 offen offset:2048 sc1
v_cvt_pk_bf16_f32 v184, 0, v184
v_cvt_pk_bf16_f32 v185, 0, v185
v_cvt_pk_bf16_f32 v186, 0, v186
v_cvt_pk_bf16_f32 v187, 0, v187
v_cvt_pk_bf16_f32 v188, 0, v188
v_cvt_pk_bf16_f32 v189, 0, v189
v_cvt_pk_bf16_f32 v190, 0, v190
v_cvt_pk_bf16_f32 v191, 0, v191
v_mul_f32 v16, s30, v184
v_mul_f32 v17, s30, v185
v_mul_f32 v18, s30, v186
v_mul_f32 v19, s30, v187
v_mul_f32 v20, s30, v188
v_mul_f32 v21, s30, v189
v_mul_f32 v22, s30, v190
v_mul_f32 v23, s30, v191
v_exp_f32 v16, v16
v_exp_f32 v17, v17
v_exp_f32 v18, v18
v_exp_f32 v19, v19
v_exp_f32 v20, v20
v_exp_f32 v21, v21
v_exp_f32 v22, v22
v_exp_f32 v23, v23
v_add_f32 v16, 1.0, v16
v_add_f32 v17, 1.0, v17
v_add_f32 v18, 1.0, v18
v_add_f32 v19, 1.0, v19
v_add_f32 v20, 1.0, v20
v_add_f32 v21, 1.0, v21
v_add_f32 v22, 1.0, v22
v_add_f32 v23, 1.0, v23
v_rcp_f32 v16, v16
v_rcp_f32 v17, v17
v_rcp_f32 v18, v18
v_rcp_f32 v19, v19
v_rcp_f32 v20, v20
v_rcp_f32 v21, v21
v_rcp_f32 v22, v22
v_rcp_f32 v23, v23
v_mul_f32 v16, v16, v184
v_mul_f32 v17, v17, v185
v_mul_f32 v18, v18, v186
v_mul_f32 v19, v19, v187
v_mul_f32 v20, v20, v188
v_mul_f32 v21, v21, v189
v_mul_f32 v22, v22, v190
v_mul_f32 v23, v23, v191
v_cvt_pk_bf16_f32 v60, v16, v17
v_cvt_pk_bf16_f32 v61, v18, v19
v_cvt_pk_bf16_f32 v62, v20, v21
v_cvt_pk_bf16_f32 v63, v22, v23
buffer_store_dwordx4 v[60:63], v14, s[36:39], s34 offen offset:2560 sc1
s_branch L_ka_fin
L_role_side:
s_load_dwordx2 s[4:5], s[0:1], 120
s_load_dwordx2 s[6:7], s[0:1], 0
s_load_dwordx2 s[8:9], s[0:1], 88
s_load_dwordx2 s[34:35], s[0:1], 96
v_lshrrev_b32 v1, 6, v0
v_and_b32 v2, 63, v0
s_sub_u32 s10, s2, 224
v_readfirstlane_b32 s11, v1
v_lshlrev_b32 v3, 4, v2
s_waitcnt lgkmcnt(0)
s_lshl_b32 s12, s10, 6
s_lshl_b32 s13, s11, 4
s_add_u32 s12, s12, s13
s_lshl_b32 s13, s12, 10
s_add_u32 s20, s6, s13
s_addc_u32 s21, s7, 0
s_and_b32 s21, s21, 0xffff
s_mov_b32 s22, 16384
s_mov_b32 s23, 0x20000
s_mov_b32 s24, s34
s_and_b32 s25, s35, 0xffff
s_mov_b32 s26, 1024
s_mov_b32 s27, 0x20000
buffer_load_dwordx4 v[8:11], v3, s[24:27], 0 offen
s_mov_b32 s14, 0
buffer_load_dwordx4 v[32:35], v3, s[20:23], s14 offen
s_mov_b32 s14, 1024
buffer_load_dwordx4 v[36:39], v3, s[20:23], s14 offen
s_mov_b32 s14, 2048
buffer_load_dwordx4 v[40:43], v3, s[20:23], s14 offen
s_mov_b32 s14, 3072
buffer_load_dwordx4 v[44:47], v3, s[20:23], s14 offen
s_mov_b32 s14, 4096
buffer_load_dwordx4 v[48:51], v3, s[20:23], s14 offen
s_mov_b32 s14, 5120
buffer_load_dwordx4 v[52:55], v3, s[20:23], s14 offen
s_mov_b32 s14, 6144
buffer_load_dwordx4 v[56:59], v3, s[20:23], s14 offen
s_mov_b32 s14, 7168
buffer_load_dwordx4 v[60:63], v3, s[20:23], s14 offen
s_mov_b32 s14, 8192
buffer_load_dwordx4 v[64:67], v3, s[20:23], s14 offen
s_mov_b32 s14, 9216
buffer_load_dwordx4 v[68:71], v3, s[20:23], s14 offen
s_mov_b32 s14, 10240
buffer_load_dwordx4 v[72:75], v3, s[20:23], s14 offen
s_mov_b32 s14, 11264
buffer_load_dwordx4 v[76:79], v3, s[20:23], s14 offen
s_mov_b32 s14, 12288
buffer_load_dwordx4 v[80:83], v3, s[20:23], s14 offen
s_mov_b32 s14, 13312
buffer_load_dwordx4 v[84:87], v3, s[20:23], s14 offen
s_mov_b32 s14, 14336
buffer_load_dwordx4 v[88:91], v3, s[20:23], s14 offen
s_mov_b32 s14, 15360
buffer_load_dwordx4 v[92:95], v3, s[20:23], s14 offen
s_cmp_ge_u32 s10, 28
s_cbranch_scc1 L_now2_1
s_mov_b32 s28, s8
s_and_b32 s29, s9, 0xffff
s_mov_b32 s30, 1835008
s_mov_b32 s31, 0x20000
s_add_u32 s36, s4, 8388608
s_addc_u32 s37, s5, 0
s_and_b32 s37, s37, 0xffff
s_mov_b32 s38, 1835008
s_mov_b32 s39, 0x20000
v_lshrrev_b32 v4, 3, v2
v_lshlrev_b32 v4, 10, v4
v_and_b32 v5, 7, v2
v_lshlrev_b32 v5, 4, v5
v_add_u32 v4, v4, v5
s_lshl_b32 s15, s10, 4
s_lshl_b32 s16, s11, 2
s_add_u32 s15, s15, s16
s_lshl_b32 s17, s11, 14
s_add_u32 s16, s15, 0
s_and_b32 s18, s16, 7
s_lshr_b32 s19, s16, 3
s_lshl_b32 s40, s19, 15
s_lshl_b32 s41, s18, 7
s_add_u32 s40, s40, s41
s_mul_i32 s41, s18, 56
s_add_u32 s41, s41, s19
s_lshl_b32 s44, s41, 12
s_add_u32 m0, s17, 0
s_add_u32 s41, s40, 0
buffer_load_dwordx4 v4, s[28:31], s41 offen offset:0 lds
s_add_u32 s41, s40, 7168
buffer_load_dwordx4 v4, s[28:31], s41 offen offset:1024 lds
s_add_u32 s41, s40, 14336
buffer_load_dwordx4 v4, s[28:31], s41 offen offset:2048 lds
s_add_u32 s41, s40, 21504
buffer_load_dwordx4 v4, s[28:31], s41 offen offset:3072 lds
s_add_u32 s16, s15, 1
s_and_b32 s18, s16, 7
s_lshr_b32 s19, s16, 3
s_lshl_b32 s40, s19, 15
s_lshl_b32 s41, s18, 7
s_add_u32 s40, s40, s41
s_mul_i32 s41, s18, 56
s_add_u32 s41, s41, s19
s_lshl_b32 s45, s41, 12
s_add_u32 m0, s17, 4096
s_add_u32 s41, s40, 0
buffer_load_dwordx4 v4, s[28:31], s41 offen offset:0 lds
s_add_u32 s41, s40, 7168
buffer_load_dwordx4 v4, s[28:31], s41 offen offset:1024 lds
s_add_u32 s41, s40, 14336
buffer_load_dwordx4 v4, s[28:31], s41 offen offset:2048 lds
s_add_u32 s41, s40, 21504
buffer_load_dwordx4 v4, s[28:31], s41 offen offset:3072 lds
s_add_u32 s16, s15, 2
s_and_b32 s18, s16, 7
s_lshr_b32 s19, s16, 3
s_lshl_b32 s40, s19, 15
s_lshl_b32 s41, s18, 7
s_add_u32 s40, s40, s41
s_mul_i32 s41, s18, 56
s_add_u32 s41, s41, s19
s_lshl_b32 s46, s41, 12
s_add_u32 m0, s17, 8192
s_add_u32 s41, s40, 0
buffer_load_dwordx4 v4, s[28:31], s41 offen offset:0 lds
s_add_u32 s41, s40, 7168
buffer_load_dwordx4 v4, s[28:31], s41 offen offset:1024 lds
s_add_u32 s41, s40, 14336
buffer_load_dwordx4 v4, s[28:31], s41 offen offset:2048 lds
s_add_u32 s41, s40, 21504
buffer_load_dwordx4 v4, s[28:31], s41 offen offset:3072 lds
s_add_u32 s16, s15, 3
s_and_b32 s18, s16, 7
s_lshr_b32 s19, s16, 3
s_lshl_b32 s40, s19, 15
s_lshl_b32 s41, s18, 7
s_add_u32 s40, s40, s41
s_mul_i32 s41, s18, 56
s_add_u32 s41, s41, s19
s_lshl_b32 s47, s41, 12
s_add_u32 m0, s17, 12288
s_add_u32 s41, s40, 0
buffer_load_dwordx4 v4, s[28:31], s41 offen offset:0 lds
s_add_u32 s41, s40, 7168
buffer_load_dwordx4 v4, s[28:31], s41 offen offset:1024 lds
s_add_u32 s41, s40, 14336
buffer_load_dwordx4 v4, s[28:31], s41 offen offset:2048 lds
s_add_u32 s41, s40, 21504
buffer_load_dwordx4 v4, s[28:31], s41 offen offset:3072 lds
v_lshrrev_b32 v5, 5, v2
v_lshlrev_b32 v5, 4, v5
v_lshrrev_b32 v6, 4, v2
v_and_b32 v6, 1, v6
v_lshlrev_b32 v6, 2, v6
v_add_u32 v5, v5, v6
v_lshrrev_b32 v6, 2, v2
v_and_b32 v6, 3, v6
v_add_u32 v5, v5, v6
v_lshlrev_b32 v5, 7, v5
v_and_b32 v6, 3, v2
v_lshlrev_b32 v6, 4, v6
v_add_u32 v5, v5, v6
v_add_u32 v5, s17, v5
s_waitcnt vmcnt(0)
ds_read_b64_tr_b16 v[96:97], v5 offset:0
ds_read_b64_tr_b16 v[98:99], v5 offset:1024
ds_read_b64_tr_b16 v[100:101], v5 offset:8
ds_read_b64_tr_b16 v[102:103], v5 offset:1032
ds_read_b64_tr_b16 v[104:105], v5 offset:64
ds_read_b64_tr_b16 v[106:107], v5 offset:1088
ds_read_b64_tr_b16 v[108:109], v5 offset:72
ds_read_b64_tr_b16 v[110:111], v5 offset:1096
ds_read_b64_tr_b16 v[112:113], v5 offset:4096
ds_read_b64_tr_b16 v[114:115], v5 offset:5120
ds_read_b64_tr_b16 v[116:117], v5 offset:4104
ds_read_b64_tr_b16 v[118:119], v5 offset:5128
ds_read_b64_tr_b16 v[120:121], v5 offset:4160
ds_read_b64_tr_b16 v[122:123], v5 offset:5184
ds_read_b64_tr_b16 v[124:125], v5 offset:4168
ds_read_b64_tr_b16 v[126:127], v5 offset:5192
s_waitcnt lgkmcnt(0)
ds_read_b64_tr_b16 v[128:129], v5 offset:8192
ds_read_b64_tr_b16 v[130:131], v5 offset:9216
ds_read_b64_tr_b16 v[132:133], v5 offset:8200
ds_read_b64_tr_b16 v[134:135], v5 offset:9224
ds_read_b64_tr_b16 v[136:137], v5 offset:8256
ds_read_b64_tr_b16 v[138:139], v5 offset:9280
ds_read_b64_tr_b16 v[140:141], v5 offset:8264
ds_read_b64_tr_b16 v[142:143], v5 offset:9288
ds_read_b64_tr_b16 v[144:145], v5 offset:12288
ds_read_b64_tr_b16 v[146:147], v5 offset:13312
ds_read_b64_tr_b16 v[148:149], v5 offset:12296
ds_read_b64_tr_b16 v[150:151], v5 offset:13320
ds_read_b64_tr_b16 v[152:153], v5 offset:12352
ds_read_b64_tr_b16 v[154:155], v5 offset:13376
ds_read_b64_tr_b16 v[156:157], v5 offset:12360
ds_read_b64_tr_b16 v[158:159], v5 offset:13384
s_waitcnt lgkmcnt(0)
buffer_store_dwordx4 v[96:99], v3, s[36:39], s44 offen offset:0 sc1
buffer_store_dwordx4 v[100:103], v3, s[36:39], s44 offen offset:1024 sc1
buffer_store_dwordx4 v[104:107], v3, s[36:39], s44 offen offset:2048 sc1
buffer_store_dwordx4 v[108:111], v3, s[36:39], s44 offen offset:3072 sc1
buffer_store_dwordx4 v[112:115], v3, s[36:39], s45 offen offset:0 sc1
buffer_store_dwordx4 v[116:119], v3, s[36:39], s45 offen offset:1024 sc1
buffer_store_dwordx4 v[120:123], v3, s[36:39], s45 offen offset:2048 sc1
buffer_store_dwordx4 v[124:127], v3, s[36:39], s45 offen offset:3072 sc1
buffer_store_dwordx4 v[128:131], v3, s[36:39], s46 offen offset:0 sc1
buffer_store_dwordx4 v[132:135], v3, s[36:39], s46 offen offset:1024 sc1
buffer_store_dwordx4 v[136:139], v3, s[36:39], s46 offen offset:2048 sc1
buffer_store_dwordx4 v[140:143], v3, s[36:39], s46 offen offset:3072 sc1
buffer_store_dwordx4 v[144:147], v3, s[36:39], s47 offen offset:0 sc1
buffer_store_dwordx4 v[148:151], v3, s[36:39], s47 offen offset:1024 sc1
buffer_store_dwordx4 v[152:155], v3, s[36:39], s47 offen offset:2048 sc1
buffer_store_dwordx4 v[156:159], v3, s[36:39], s47 offen offset:3072 sc1
L_now2_1:
s_waitcnt vmcnt(0)
s_mov_b32 s31, 0xffff0000
v_lshlrev_b32 v16, 16, v8
v_and_b32 v17, s31, v8
v_lshlrev_b32 v18, 16, v9
v_and_b32 v19, s31, v9
v_lshlrev_b32 v20, 16, v10
v_and_b32 v21, s31, v10
v_lshlrev_b32 v22, 16, v11
v_and_b32 v23, s31, v11
v_lshlrev_b32 v24, 16, v32
v_and_b32 v25, s31, v32
v_mul_f32 v24, v24, v16
v_mul_f32 v25, v25, v17
v_cvt_pk_bf16_f32 v26, v24, v25
v_lshlrev_b32 v24, 16, v26
v_and_b32 v25, s31, v26
v_add_f32 v160, v24, v25
v_lshlrev_b32 v24, 16, v33
v_and_b32 v25, s31, v33
v_mul_f32 v24, v24, v18
v_mul_f32 v25, v25, v19
v_cvt_pk_bf16_f32 v26, v24, v25
v_lshlrev_b32 v24, 16, v26
v_and_b32 v25, s31, v26
v_add_f32 v24, v24, v25
v_add_f32 v160, v160, v24
v_lshlrev_b32 v24, 16, v34
v_and_b32 v25, s31, v34
v_mul_f32 v24, v24, v20
v_mul_f32 v25, v25, v21
v_cvt_pk_bf16_f32 v26, v24, v25
v_lshlrev_b32 v24, 16, v26
v_and_b32 v25, s31, v26
v_add_f32 v24, v24, v25
v_add_f32 v160, v160, v24
v_lshlrev_b32 v24, 16, v35
v_and_b32 v25, s31, v35
v_mul_f32 v24, v24, v22
v_mul_f32 v25, v25, v23
v_cvt_pk_bf16_f32 v26, v24, v25
v_lshlrev_b32 v24, 16, v26
v_and_b32 v25, s31, v26
v_add_f32 v24, v24, v25
v_add_f32 v160, v160, v24
v_lshlrev_b32 v24, 16, v36
v_and_b32 v25, s31, v36
v_mul_f32 v24, v24, v16
v_mul_f32 v25, v25, v17
v_cvt_pk_bf16_f32 v26, v24, v25
v_lshlrev_b32 v24, 16, v26
v_and_b32 v25, s31, v26
v_add_f32 v161, v24, v25
v_lshlrev_b32 v24, 16, v37
v_and_b32 v25, s31, v37
v_mul_f32 v24, v24, v18
v_mul_f32 v25, v25, v19
v_cvt_pk_bf16_f32 v26, v24, v25
v_lshlrev_b32 v24, 16, v26
v_and_b32 v25, s31, v26
v_add_f32 v24, v24, v25
v_add_f32 v161, v161, v24
v_lshlrev_b32 v24, 16, v38
v_and_b32 v25, s31, v38
v_mul_f32 v24, v24, v20
v_mul_f32 v25, v25, v21
v_cvt_pk_bf16_f32 v26, v24, v25
v_lshlrev_b32 v24, 16, v26
v_and_b32 v25, s31, v26
v_add_f32 v24, v24, v25
v_add_f32 v161, v161, v24
v_lshlrev_b32 v24, 16, v39
v_and_b32 v25, s31, v39
v_mul_f32 v24, v24, v22
v_mul_f32 v25, v25, v23
v_cvt_pk_bf16_f32 v26, v24, v25
v_lshlrev_b32 v24, 16, v26
v_and_b32 v25, s31, v26
v_add_f32 v24, v24, v25
v_add_f32 v161, v161, v24
v_lshlrev_b32 v24, 16, v40
v_and_b32 v25, s31, v40
v_mul_f32 v24, v24, v16
v_mul_f32 v25, v25, v17
v_cvt_pk_bf16_f32 v26, v24, v25
v_lshlrev_b32 v24, 16, v26
v_and_b32 v25, s31, v26
v_add_f32 v162, v24, v25
v_lshlrev_b32 v24, 16, v41
v_and_b32 v25, s31, v41
v_mul_f32 v24, v24, v18
v_mul_f32 v25, v25, v19
v_cvt_pk_bf16_f32 v26, v24, v25
v_lshlrev_b32 v24, 16, v26
v_and_b32 v25, s31, v26
v_add_f32 v24, v24, v25
v_add_f32 v162, v162, v24
v_lshlrev_b32 v24, 16, v42
v_and_b32 v25, s31, v42
v_mul_f32 v24, v24, v20
v_mul_f32 v25, v25, v21
v_cvt_pk_bf16_f32 v26, v24, v25
v_lshlrev_b32 v24, 16, v26
v_and_b32 v25, s31, v26
v_add_f32 v24, v24, v25
v_add_f32 v162, v162, v24
v_lshlrev_b32 v24, 16, v43
v_and_b32 v25, s31, v43
v_mul_f32 v24, v24, v22
v_mul_f32 v25, v25, v23
v_cvt_pk_bf16_f32 v26, v24, v25
v_lshlrev_b32 v24, 16, v26
v_and_b32 v25, s31, v26
v_add_f32 v24, v24, v25
v_add_f32 v162, v162, v24
v_lshlrev_b32 v24, 16, v44
v_and_b32 v25, s31, v44
v_mul_f32 v24, v24, v16
v_mul_f32 v25, v25, v17
v_cvt_pk_bf16_f32 v26, v24, v25
v_lshlrev_b32 v24, 16, v26
v_and_b32 v25, s31, v26
v_add_f32 v163, v24, v25
v_lshlrev_b32 v24, 16, v45
v_and_b32 v25, s31, v45
v_mul_f32 v24, v24, v18
v_mul_f32 v25, v25, v19
v_cvt_pk_bf16_f32 v26, v24, v25
v_lshlrev_b32 v24, 16, v26
v_and_b32 v25, s31, v26
v_add_f32 v24, v24, v25
v_add_f32 v163, v163, v24
v_lshlrev_b32 v24, 16, v46
v_and_b32 v25, s31, v46
v_mul_f32 v24, v24, v20
v_mul_f32 v25, v25, v21
v_cvt_pk_bf16_f32 v26, v24, v25
v_lshlrev_b32 v24, 16, v26
v_and_b32 v25, s31, v26
v_add_f32 v24, v24, v25
v_add_f32 v163, v163, v24
v_lshlrev_b32 v24, 16, v47
v_and_b32 v25, s31, v47
v_mul_f32 v24, v24, v22
v_mul_f32 v25, v25, v23
v_cvt_pk_bf16_f32 v26, v24, v25
v_lshlrev_b32 v24, 16, v26
v_and_b32 v25, s31, v26
v_add_f32 v24, v24, v25
v_add_f32 v163, v163, v24
v_lshlrev_b32 v24, 16, v48
v_and_b32 v25, s31, v48
v_mul_f32 v24, v24, v16
v_mul_f32 v25, v25, v17
v_cvt_pk_bf16_f32 v26, v24, v25
v_lshlrev_b32 v24, 16, v26
v_and_b32 v25, s31, v26
v_add_f32 v164, v24, v25
v_lshlrev_b32 v24, 16, v49
v_and_b32 v25, s31, v49
v_mul_f32 v24, v24, v18
v_mul_f32 v25, v25, v19
v_cvt_pk_bf16_f32 v26, v24, v25
v_lshlrev_b32 v24, 16, v26
v_and_b32 v25, s31, v26
v_add_f32 v24, v24, v25
v_add_f32 v164, v164, v24
v_lshlrev_b32 v24, 16, v50
v_and_b32 v25, s31, v50
v_mul_f32 v24, v24, v20
v_mul_f32 v25, v25, v21
v_cvt_pk_bf16_f32 v26, v24, v25
v_lshlrev_b32 v24, 16, v26
v_and_b32 v25, s31, v26
v_add_f32 v24, v24, v25
v_add_f32 v164, v164, v24
v_lshlrev_b32 v24, 16, v51
v_and_b32 v25, s31, v51
v_mul_f32 v24, v24, v22
v_mul_f32 v25, v25, v23
v_cvt_pk_bf16_f32 v26, v24, v25
v_lshlrev_b32 v24, 16, v26
v_and_b32 v25, s31, v26
v_add_f32 v24, v24, v25
v_add_f32 v164, v164, v24
v_lshlrev_b32 v24, 16, v52
v_and_b32 v25, s31, v52
v_mul_f32 v24, v24, v16
v_mul_f32 v25, v25, v17
v_cvt_pk_bf16_f32 v26, v24, v25
v_lshlrev_b32 v24, 16, v26
v_and_b32 v25, s31, v26
v_add_f32 v165, v24, v25
v_lshlrev_b32 v24, 16, v53
v_and_b32 v25, s31, v53
v_mul_f32 v24, v24, v18
v_mul_f32 v25, v25, v19
v_cvt_pk_bf16_f32 v26, v24, v25
v_lshlrev_b32 v24, 16, v26
v_and_b32 v25, s31, v26
v_add_f32 v24, v24, v25
v_add_f32 v165, v165, v24
v_lshlrev_b32 v24, 16, v54
v_and_b32 v25, s31, v54
v_mul_f32 v24, v24, v20
v_mul_f32 v25, v25, v21
v_cvt_pk_bf16_f32 v26, v24, v25
v_lshlrev_b32 v24, 16, v26
v_and_b32 v25, s31, v26
v_add_f32 v24, v24, v25
v_add_f32 v165, v165, v24
v_lshlrev_b32 v24, 16, v55
v_and_b32 v25, s31, v55
v_mul_f32 v24, v24, v22
v_mul_f32 v25, v25, v23
v_cvt_pk_bf16_f32 v26, v24, v25
v_lshlrev_b32 v24, 16, v26
v_and_b32 v25, s31, v26
v_add_f32 v24, v24, v25
v_add_f32 v165, v165, v24
v_lshlrev_b32 v24, 16, v56
v_and_b32 v25, s31, v56
v_mul_f32 v24, v24, v16
v_mul_f32 v25, v25, v17
v_cvt_pk_bf16_f32 v26, v24, v25
v_lshlrev_b32 v24, 16, v26
v_and_b32 v25, s31, v26
v_add_f32 v166, v24, v25
v_lshlrev_b32 v24, 16, v57
v_and_b32 v25, s31, v57
v_mul_f32 v24, v24, v18
v_mul_f32 v25, v25, v19
v_cvt_pk_bf16_f32 v26, v24, v25
v_lshlrev_b32 v24, 16, v26
v_and_b32 v25, s31, v26
v_add_f32 v24, v24, v25
v_add_f32 v166, v166, v24
v_lshlrev_b32 v24, 16, v58
v_and_b32 v25, s31, v58
v_mul_f32 v24, v24, v20
v_mul_f32 v25, v25, v21
v_cvt_pk_bf16_f32 v26, v24, v25
v_lshlrev_b32 v24, 16, v26
v_and_b32 v25, s31, v26
v_add_f32 v24, v24, v25
v_add_f32 v166, v166, v24
v_lshlrev_b32 v24, 16, v59
v_and_b32 v25, s31, v59
v_mul_f32 v24, v24, v22
v_mul_f32 v25, v25, v23
v_cvt_pk_bf16_f32 v26, v24, v25
v_lshlrev_b32 v24, 16, v26
v_and_b32 v25, s31, v26
v_add_f32 v24, v24, v25
v_add_f32 v166, v166, v24
v_lshlrev_b32 v24, 16, v60
v_and_b32 v25, s31, v60
v_mul_f32 v24, v24, v16
v_mul_f32 v25, v25, v17
v_cvt_pk_bf16_f32 v26, v24, v25
v_lshlrev_b32 v24, 16, v26
v_and_b32 v25, s31, v26
v_add_f32 v167, v24, v25
v_lshlrev_b32 v24, 16, v61
v_and_b32 v25, s31, v61
v_mul_f32 v24, v24, v18
v_mul_f32 v25, v25, v19
v_cvt_pk_bf16_f32 v26, v24, v25
v_lshlrev_b32 v24, 16, v26
v_and_b32 v25, s31, v26
v_add_f32 v24, v24, v25
v_add_f32 v167, v167, v24
v_lshlrev_b32 v24, 16, v62
v_and_b32 v25, s31, v62
v_mul_f32 v24, v24, v20
v_mul_f32 v25, v25, v21
v_cvt_pk_bf16_f32 v26, v24, v25
v_lshlrev_b32 v24, 16, v26
v_and_b32 v25, s31, v26
v_add_f32 v24, v24, v25
v_add_f32 v167, v167, v24
v_lshlrev_b32 v24, 16, v63
v_and_b32 v25, s31, v63
v_mul_f32 v24, v24, v22
v_mul_f32 v25, v25, v23
v_cvt_pk_bf16_f32 v26, v24, v25
v_lshlrev_b32 v24, 16, v26
v_and_b32 v25, s31, v26
v_add_f32 v24, v24, v25
v_add_f32 v167, v167, v24
v_lshlrev_b32 v24, 16, v64
v_and_b32 v25, s31, v64
v_mul_f32 v24, v24, v16
v_mul_f32 v25, v25, v17
v_cvt_pk_bf16_f32 v26, v24, v25
v_lshlrev_b32 v24, 16, v26
v_and_b32 v25, s31, v26
v_add_f32 v168, v24, v25
v_lshlrev_b32 v24, 16, v65
v_and_b32 v25, s31, v65
v_mul_f32 v24, v24, v18
v_mul_f32 v25, v25, v19
v_cvt_pk_bf16_f32 v26, v24, v25
v_lshlrev_b32 v24, 16, v26
v_and_b32 v25, s31, v26
v_add_f32 v24, v24, v25
v_add_f32 v168, v168, v24
v_lshlrev_b32 v24, 16, v66
v_and_b32 v25, s31, v66
v_mul_f32 v24, v24, v20
v_mul_f32 v25, v25, v21
v_cvt_pk_bf16_f32 v26, v24, v25
v_lshlrev_b32 v24, 16, v26
v_and_b32 v25, s31, v26
v_add_f32 v24, v24, v25
v_add_f32 v168, v168, v24
v_lshlrev_b32 v24, 16, v67
v_and_b32 v25, s31, v67
v_mul_f32 v24, v24, v22
v_mul_f32 v25, v25, v23
v_cvt_pk_bf16_f32 v26, v24, v25
v_lshlrev_b32 v24, 16, v26
v_and_b32 v25, s31, v26
v_add_f32 v24, v24, v25
v_add_f32 v168, v168, v24
v_lshlrev_b32 v24, 16, v68
v_and_b32 v25, s31, v68
v_mul_f32 v24, v24, v16
v_mul_f32 v25, v25, v17
v_cvt_pk_bf16_f32 v26, v24, v25
v_lshlrev_b32 v24, 16, v26
v_and_b32 v25, s31, v26
v_add_f32 v169, v24, v25
v_lshlrev_b32 v24, 16, v69
v_and_b32 v25, s31, v69
v_mul_f32 v24, v24, v18
v_mul_f32 v25, v25, v19
v_cvt_pk_bf16_f32 v26, v24, v25
v_lshlrev_b32 v24, 16, v26
v_and_b32 v25, s31, v26
v_add_f32 v24, v24, v25
v_add_f32 v169, v169, v24
v_lshlrev_b32 v24, 16, v70
v_and_b32 v25, s31, v70
v_mul_f32 v24, v24, v20
v_mul_f32 v25, v25, v21
v_cvt_pk_bf16_f32 v26, v24, v25
v_lshlrev_b32 v24, 16, v26
v_and_b32 v25, s31, v26
v_add_f32 v24, v24, v25
v_add_f32 v169, v169, v24
v_lshlrev_b32 v24, 16, v71
v_and_b32 v25, s31, v71
v_mul_f32 v24, v24, v22
v_mul_f32 v25, v25, v23
v_cvt_pk_bf16_f32 v26, v24, v25
v_lshlrev_b32 v24, 16, v26
v_and_b32 v25, s31, v26
v_add_f32 v24, v24, v25
v_add_f32 v169, v169, v24
v_lshlrev_b32 v24, 16, v72
v_and_b32 v25, s31, v72
v_mul_f32 v24, v24, v16
v_mul_f32 v25, v25, v17
v_cvt_pk_bf16_f32 v26, v24, v25
v_lshlrev_b32 v24, 16, v26
v_and_b32 v25, s31, v26
v_add_f32 v170, v24, v25
v_lshlrev_b32 v24, 16, v73
v_and_b32 v25, s31, v73
v_mul_f32 v24, v24, v18
v_mul_f32 v25, v25, v19
v_cvt_pk_bf16_f32 v26, v24, v25
v_lshlrev_b32 v24, 16, v26
v_and_b32 v25, s31, v26
v_add_f32 v24, v24, v25
v_add_f32 v170, v170, v24
v_lshlrev_b32 v24, 16, v74
v_and_b32 v25, s31, v74
v_mul_f32 v24, v24, v20
v_mul_f32 v25, v25, v21
v_cvt_pk_bf16_f32 v26, v24, v25
v_lshlrev_b32 v24, 16, v26
v_and_b32 v25, s31, v26
v_add_f32 v24, v24, v25
v_add_f32 v170, v170, v24
v_lshlrev_b32 v24, 16, v75
v_and_b32 v25, s31, v75
v_mul_f32 v24, v24, v22
v_mul_f32 v25, v25, v23
v_cvt_pk_bf16_f32 v26, v24, v25
v_lshlrev_b32 v24, 16, v26
v_and_b32 v25, s31, v26
v_add_f32 v24, v24, v25
v_add_f32 v170, v170, v24
v_lshlrev_b32 v24, 16, v76
v_and_b32 v25, s31, v76
v_mul_f32 v24, v24, v16
v_mul_f32 v25, v25, v17
v_cvt_pk_bf16_f32 v26, v24, v25
v_lshlrev_b32 v24, 16, v26
v_and_b32 v25, s31, v26
v_add_f32 v171, v24, v25
v_lshlrev_b32 v24, 16, v77
v_and_b32 v25, s31, v77
v_mul_f32 v24, v24, v18
v_mul_f32 v25, v25, v19
v_cvt_pk_bf16_f32 v26, v24, v25
v_lshlrev_b32 v24, 16, v26
v_and_b32 v25, s31, v26
v_add_f32 v24, v24, v25
v_add_f32 v171, v171, v24
v_lshlrev_b32 v24, 16, v78
v_and_b32 v25, s31, v78
v_mul_f32 v24, v24, v20
v_mul_f32 v25, v25, v21
v_cvt_pk_bf16_f32 v26, v24, v25
v_lshlrev_b32 v24, 16, v26
v_and_b32 v25, s31, v26
v_add_f32 v24, v24, v25
v_add_f32 v171, v171, v24
v_lshlrev_b32 v24, 16, v79
v_and_b32 v25, s31, v79
v_mul_f32 v24, v24, v22
v_mul_f32 v25, v25, v23
v_cvt_pk_bf16_f32 v26, v24, v25
v_lshlrev_b32 v24, 16, v26
v_and_b32 v25, s31, v26
v_add_f32 v24, v24, v25
v_add_f32 v171, v171, v24
v_lshlrev_b32 v24, 16, v80
v_and_b32 v25, s31, v80
v_mul_f32 v24, v24, v16
v_mul_f32 v25, v25, v17
v_cvt_pk_bf16_f32 v26, v24, v25
v_lshlrev_b32 v24, 16, v26
v_and_b32 v25, s31, v26
v_add_f32 v172, v24, v25
v_lshlrev_b32 v24, 16, v81
v_and_b32 v25, s31, v81
v_mul_f32 v24, v24, v18
v_mul_f32 v25, v25, v19
v_cvt_pk_bf16_f32 v26, v24, v25
v_lshlrev_b32 v24, 16, v26
v_and_b32 v25, s31, v26
v_add_f32 v24, v24, v25
v_add_f32 v172, v172, v24
v_lshlrev_b32 v24, 16, v82
v_and_b32 v25, s31, v82
v_mul_f32 v24, v24, v20
v_mul_f32 v25, v25, v21
v_cvt_pk_bf16_f32 v26, v24, v25
v_lshlrev_b32 v24, 16, v26
v_and_b32 v25, s31, v26
v_add_f32 v24, v24, v25
v_add_f32 v172, v172, v24
v_lshlrev_b32 v24, 16, v83
v_and_b32 v25, s31, v83
v_mul_f32 v24, v24, v22
v_mul_f32 v25, v25, v23
v_cvt_pk_bf16_f32 v26, v24, v25
v_lshlrev_b32 v24, 16, v26
v_and_b32 v25, s31, v26
v_add_f32 v24, v24, v25
v_add_f32 v172, v172, v24
v_lshlrev_b32 v24, 16, v84
v_and_b32 v25, s31, v84
v_mul_f32 v24, v24, v16
v_mul_f32 v25, v25, v17
v_cvt_pk_bf16_f32 v26, v24, v25
v_lshlrev_b32 v24, 16, v26
v_and_b32 v25, s31, v26
v_add_f32 v173, v24, v25
v_lshlrev_b32 v24, 16, v85
v_and_b32 v25, s31, v85
v_mul_f32 v24, v24, v18
v_mul_f32 v25, v25, v19
v_cvt_pk_bf16_f32 v26, v24, v25
v_lshlrev_b32 v24, 16, v26
v_and_b32 v25, s31, v26
v_add_f32 v24, v24, v25
v_add_f32 v173, v173, v24
v_lshlrev_b32 v24, 16, v86
v_and_b32 v25, s31, v86
v_mul_f32 v24, v24, v20
v_mul_f32 v25, v25, v21
v_cvt_pk_bf16_f32 v26, v24, v25
v_lshlrev_b32 v24, 16, v26
v_and_b32 v25, s31, v26
v_add_f32 v24, v24, v25
v_add_f32 v173, v173, v24
v_lshlrev_b32 v24, 16, v87
v_and_b32 v25, s31, v87
v_mul_f32 v24, v24, v22
v_mul_f32 v25, v25, v23
v_cvt_pk_bf16_f32 v26, v24, v25
v_lshlrev_b32 v24, 16, v26
v_and_b32 v25, s31, v26
v_add_f32 v24, v24, v25
v_add_f32 v173, v173, v24
v_lshlrev_b32 v24, 16, v88
v_and_b32 v25, s31, v88
v_mul_f32 v24, v24, v16
v_mul_f32 v25, v25, v17
v_cvt_pk_bf16_f32 v26, v24, v25
v_lshlrev_b32 v24, 16, v26
v_and_b32 v25, s31, v26
v_add_f32 v174, v24, v25
v_lshlrev_b32 v24, 16, v89
v_and_b32 v25, s31, v89
v_mul_f32 v24, v24, v18
v_mul_f32 v25, v25, v19
v_cvt_pk_bf16_f32 v26, v24, v25
v_lshlrev_b32 v24, 16, v26
v_and_b32 v25, s31, v26
v_add_f32 v24, v24, v25
v_add_f32 v174, v174, v24
v_lshlrev_b32 v24, 16, v90
v_and_b32 v25, s31, v90
v_mul_f32 v24, v24, v20
v_mul_f32 v25, v25, v21
v_cvt_pk_bf16_f32 v26, v24, v25
v_lshlrev_b32 v24, 16, v26
v_and_b32 v25, s31, v26
v_add_f32 v24, v24, v25
v_add_f32 v174, v174, v24
v_lshlrev_b32 v24, 16, v91
v_and_b32 v25, s31, v91
v_mul_f32 v24, v24, v22
v_mul_f32 v25, v25, v23
v_cvt_pk_bf16_f32 v26, v24, v25
v_lshlrev_b32 v24, 16, v26
v_and_b32 v25, s31, v26
v_add_f32 v24, v24, v25
v_add_f32 v174, v174, v24
v_lshlrev_b32 v24, 16, v92
v_and_b32 v25, s31, v92
v_mul_f32 v24, v24, v16
v_mul_f32 v25, v25, v17
v_cvt_pk_bf16_f32 v26, v24, v25
v_lshlrev_b32 v24, 16, v26
v_and_b32 v25, s31, v26
v_add_f32 v175, v24, v25
v_lshlrev_b32 v24, 16, v93
v_and_b32 v25, s31, v93
v_mul_f32 v24, v24, v18
v_mul_f32 v25, v25, v19
v_cvt_pk_bf16_f32 v26, v24, v25
v_lshlrev_b32 v24, 16, v26
v_and_b32 v25, s31, v26
v_add_f32 v24, v24, v25
v_add_f32 v175, v175, v24
v_lshlrev_b32 v24, 16, v94
v_and_b32 v25, s31, v94
v_mul_f32 v24, v24, v20
v_mul_f32 v25, v25, v21
v_cvt_pk_bf16_f32 v26, v24, v25
v_lshlrev_b32 v24, 16, v26
v_and_b32 v25, s31, v26
v_add_f32 v24, v24, v25
v_add_f32 v175, v175, v24
v_lshlrev_b32 v24, 16, v95
v_and_b32 v25, s31, v95
v_mul_f32 v24, v24, v22
v_mul_f32 v25, v25, v23
v_cvt_pk_bf16_f32 v26, v24, v25
v_lshlrev_b32 v24, 16, v26
v_and_b32 v25, s31, v26
v_add_f32 v24, v24, v25
v_add_f32 v175, v175, v24
v_add_f32_dpp v160, v160, v160 row_shr:1 row_mask:0xf bank_mask:0xf bound_ctrl:0
v_add_f32_dpp v161, v161, v161 row_shr:1 row_mask:0xf bank_mask:0xf bound_ctrl:0
v_add_f32_dpp v162, v162, v162 row_shr:1 row_mask:0xf bank_mask:0xf bound_ctrl:0
v_add_f32_dpp v163, v163, v163 row_shr:1 row_mask:0xf bank_mask:0xf bound_ctrl:0
v_add_f32_dpp v164, v164, v164 row_shr:1 row_mask:0xf bank_mask:0xf bound_ctrl:0
v_add_f32_dpp v165, v165, v165 row_shr:1 row_mask:0xf bank_mask:0xf bound_ctrl:0
v_add_f32_dpp v166, v166, v166 row_shr:1 row_mask:0xf bank_mask:0xf bound_ctrl:0
v_add_f32_dpp v167, v167, v167 row_shr:1 row_mask:0xf bank_mask:0xf bound_ctrl:0
v_add_f32_dpp v168, v168, v168 row_shr:1 row_mask:0xf bank_mask:0xf bound_ctrl:0
v_add_f32_dpp v169, v169, v169 row_shr:1 row_mask:0xf bank_mask:0xf bound_ctrl:0
v_add_f32_dpp v170, v170, v170 row_shr:1 row_mask:0xf bank_mask:0xf bound_ctrl:0
v_add_f32_dpp v171, v171, v171 row_shr:1 row_mask:0xf bank_mask:0xf bound_ctrl:0
v_add_f32_dpp v172, v172, v172 row_shr:1 row_mask:0xf bank_mask:0xf bound_ctrl:0
v_add_f32_dpp v173, v173, v173 row_shr:1 row_mask:0xf bank_mask:0xf bound_ctrl:0
v_add_f32_dpp v174, v174, v174 row_shr:1 row_mask:0xf bank_mask:0xf bound_ctrl:0
v_add_f32_dpp v175, v175, v175 row_shr:1 row_mask:0xf bank_mask:0xf bound_ctrl:0
v_add_f32_dpp v160, v160, v160 row_shr:2 row_mask:0xf bank_mask:0xf bound_ctrl:0
v_add_f32_dpp v161, v161, v161 row_shr:2 row_mask:0xf bank_mask:0xf bound_ctrl:0
v_add_f32_dpp v162, v162, v162 row_shr:2 row_mask:0xf bank_mask:0xf bound_ctrl:0
v_add_f32_dpp v163, v163, v163 row_shr:2 row_mask:0xf bank_mask:0xf bound_ctrl:0
v_add_f32_dpp v164, v164, v164 row_shr:2 row_mask:0xf bank_mask:0xf bound_ctrl:0
v_add_f32_dpp v165, v165, v165 row_shr:2 row_mask:0xf bank_mask:0xf bound_ctrl:0
v_add_f32_dpp v166, v166, v166 row_shr:2 row_mask:0xf bank_mask:0xf bound_ctrl:0
v_add_f32_dpp v167, v167, v167 row_shr:2 row_mask:0xf bank_mask:0xf bound_ctrl:0
v_add_f32_dpp v168, v168, v168 row_shr:2 row_mask:0xf bank_mask:0xf bound_ctrl:0
v_add_f32_dpp v169, v169, v169 row_shr:2 row_mask:0xf bank_mask:0xf bound_ctrl:0
v_add_f32_dpp v170, v170, v170 row_shr:2 row_mask:0xf bank_mask:0xf bound_ctrl:0
v_add_f32_dpp v171, v171, v171 row_shr:2 row_mask:0xf bank_mask:0xf bound_ctrl:0
v_add_f32_dpp v172, v172, v172 row_shr:2 row_mask:0xf bank_mask:0xf bound_ctrl:0
v_add_f32_dpp v173, v173, v173 row_shr:2 row_mask:0xf bank_mask:0xf bound_ctrl:0
v_add_f32_dpp v174, v174, v174 row_shr:2 row_mask:0xf bank_mask:0xf bound_ctrl:0
v_add_f32_dpp v175, v175, v175 row_shr:2 row_mask:0xf bank_mask:0xf bound_ctrl:0
v_add_f32_dpp v160, v160, v160 row_shr:4 row_mask:0xf bank_mask:0xf bound_ctrl:0
v_add_f32_dpp v161, v161, v161 row_shr:4 row_mask:0xf bank_mask:0xf bound_ctrl:0
v_add_f32_dpp v162, v162, v162 row_shr:4 row_mask:0xf bank_mask:0xf bound_ctrl:0
v_add_f32_dpp v163, v163, v163 row_shr:4 row_mask:0xf bank_mask:0xf bound_ctrl:0
v_add_f32_dpp v164, v164, v164 row_shr:4 row_mask:0xf bank_mask:0xf bound_ctrl:0
v_add_f32_dpp v165, v165, v165 row_shr:4 row_mask:0xf bank_mask:0xf bound_ctrl:0
v_add_f32_dpp v166, v166, v166 row_shr:4 row_mask:0xf bank_mask:0xf bound_ctrl:0
v_add_f32_dpp v167, v167, v167 row_shr:4 row_mask:0xf bank_mask:0xf bound_ctrl:0
v_add_f32_dpp v168, v168, v168 row_shr:4 row_mask:0xf bank_mask:0xf bound_ctrl:0
v_add_f32_dpp v169, v169, v169 row_shr:4 row_mask:0xf bank_mask:0xf bound_ctrl:0
v_add_f32_dpp v170, v170, v170 row_shr:4 row_mask:0xf bank_mask:0xf bound_ctrl:0
v_add_f32_dpp v171, v171, v171 row_shr:4 row_mask:0xf bank_mask:0xf bound_ctrl:0
v_add_f32_dpp v172, v172, v172 row_shr:4 row_mask:0xf bank_mask:0xf bound_ctrl:0
v_add_f32_dpp v173, v173, v173 row_shr:4 row_mask:0xf bank_mask:0xf bound_ctrl:0
v_add_f32_dpp v174, v174, v174 row_shr:4 row_mask:0xf bank_mask:0xf bound_ctrl:0
v_add_f32_dpp v175, v175, v175 row_shr:4 row_mask:0xf bank_mask:0xf bound_ctrl:0
v_add_f32_dpp v160, v160, v160 row_shr:8 row_mask:0xf bank_mask:0xf bound_ctrl:0
v_add_f32_dpp v161, v161, v161 row_shr:8 row_mask:0xf bank_mask:0xf bound_ctrl:0
v_add_f32_dpp v162, v162, v162 row_shr:8 row_mask:0xf bank_mask:0xf bound_ctrl:0
v_add_f32_dpp v163, v163, v163 row_shr:8 row_mask:0xf bank_mask:0xf bound_ctrl:0
v_add_f32_dpp v164, v164, v164 row_shr:8 row_mask:0xf bank_mask:0xf bound_ctrl:0
v_add_f32_dpp v165, v165, v165 row_shr:8 row_mask:0xf bank_mask:0xf bound_ctrl:0
v_add_f32_dpp v166, v166, v166 row_shr:8 row_mask:0xf bank_mask:0xf bound_ctrl:0
v_add_f32_dpp v167, v167, v167 row_shr:8 row_mask:0xf bank_mask:0xf bound_ctrl:0
v_add_f32_dpp v168, v168, v168 row_shr:8 row_mask:0xf bank_mask:0xf bound_ctrl:0
v_add_f32_dpp v169, v169, v169 row_shr:8 row_mask:0xf bank_mask:0xf bound_ctrl:0
v_add_f32_dpp v170, v170, v170 row_shr:8 row_mask:0xf bank_mask:0xf bound_ctrl:0
v_add_f32_dpp v171, v171, v171 row_shr:8 row_mask:0xf bank_mask:0xf bound_ctrl:0
v_add_f32_dpp v172, v172, v172 row_shr:8 row_mask:0xf bank_mask:0xf bound_ctrl:0
v_add_f32_dpp v173, v173, v173 row_shr:8 row_mask:0xf bank_mask:0xf bound_ctrl:0
v_add_f32_dpp v174, v174, v174 row_shr:8 row_mask:0xf bank_mask:0xf bound_ctrl:0
v_add_f32_dpp v175, v175, v175 row_shr:8 row_mask:0xf bank_mask:0xf bound_ctrl:0
v_add_f32_dpp v160, v160, v160 row_bcast:15 row_mask:0xa bank_mask:0xf
v_add_f32_dpp v161, v161, v161 row_bcast:15 row_mask:0xa bank_mask:0xf
v_add_f32_dpp v162, v162, v162 row_bcast:15 row_mask:0xa bank_mask:0xf
v_add_f32_dpp v163, v163, v163 row_bcast:15 row_mask:0xa bank_mask:0xf
v_add_f32_dpp v164, v164, v164 row_bcast:15 row_mask:0xa bank_mask:0xf
v_add_f32_dpp v165, v165, v165 row_bcast:15 row_mask:0xa bank_mask:0xf
v_add_f32_dpp v166, v166, v166 row_bcast:15 row_mask:0xa bank_mask:0xf
v_add_f32_dpp v167, v167, v167 row_bcast:15 row_mask:0xa bank_mask:0xf
v_add_f32_dpp v168, v168, v168 row_bcast:15 row_mask:0xa bank_mask:0xf
v_add_f32_dpp v169, v169, v169 row_bcast:15 row_mask:0xa bank_mask:0xf
v_add_f32_dpp v170, v170, v170 row_bcast:15 row_mask:0xa bank_mask:0xf
v_add_f32_dpp v171, v171, v171 row_bcast:15 row_mask:0xa bank_mask:0xf
v_add_f32_dpp v172, v172, v172 row_bcast:15 row_mask:0xa bank_mask:0xf
v_add_f32_dpp v173, v173, v173 row_bcast:15 row_mask:0xa bank_mask:0xf
v_add_f32_dpp v174, v174, v174 row_bcast:15 row_mask:0xa bank_mask:0xf
v_add_f32_dpp v175, v175, v175 row_bcast:15 row_mask:0xa bank_mask:0xf
v_add_f32_dpp v160, v160, v160 row_bcast:31 row_mask:0xc bank_mask:0xf
v_add_f32_dpp v161, v161, v161 row_bcast:31 row_mask:0xc bank_mask:0xf
v_add_f32_dpp v162, v162, v162 row_bcast:31 row_mask:0xc bank_mask:0xf
v_add_f32_dpp v163, v163, v163 row_bcast:31 row_mask:0xc bank_mask:0xf
v_add_f32_dpp v164, v164, v164 row_bcast:31 row_mask:0xc bank_mask:0xf
v_add_f32_dpp v165, v165, v165 row_bcast:31 row_mask:0xc bank_mask:0xf
v_add_f32_dpp v166, v166, v166 row_bcast:31 row_mask:0xc bank_mask:0xf
v_add_f32_dpp v167, v167, v167 row_bcast:31 row_mask:0xc bank_mask:0xf
v_add_f32_dpp v168, v168, v168 row_bcast:31 row_mask:0xc bank_mask:0xf
v_add_f32_dpp v169, v169, v169 row_bcast:31 row_mask:0xc bank_mask:0xf
v_add_f32_dpp v170, v170, v170 row_bcast:31 row_mask:0xc bank_mask:0xf
v_add_f32_dpp v171, v171, v171 row_bcast:31 row_mask:0xc bank_mask:0xf
v_add_f32_dpp v172, v172, v172 row_bcast:31 row_mask:0xc bank_mask:0xf
v_add_f32_dpp v173, v173, v173 row_bcast:31 row_mask:0xc bank_mask:0xf
v_add_f32_dpp v174, v174, v174 row_bcast:31 row_mask:0xc bank_mask:0xf
v_add_f32_dpp v175, v175, v175 row_bcast:31 row_mask:0xc bank_mask:0xf
v_mov_b32 v24, 0
s_nop 1
v_readlane_b32 s44, v160, 63
s_nop 3
v_writelane_b32 v24, s44, 0
v_readlane_b32 s45, v161, 63
s_nop 3
v_writelane_b32 v24, s45, 1
v_readlane_b32 s46, v162, 63
s_nop 3
v_writelane_b32 v24, s46, 2
v_readlane_b32 s47, v163, 63
s_nop 3
v_writelane_b32 v24, s47, 3
v_readlane_b32 s44, v164, 63
s_nop 3
v_writelane_b32 v24, s44, 4
v_readlane_b32 s45, v165, 63
s_nop 3
v_writelane_b32 v24, s45, 5
v_readlane_b32 s46, v166, 63
s_nop 3
v_writelane_b32 v24, s46, 6
v_readlane_b32 s47, v167, 63
s_nop 3
v_writelane_b32 v24, s47, 7
v_readlane_b32 s44, v168, 63
s_nop 3
v_writelane_b32 v24, s44, 8
v_readlane_b32 s45, v169, 63
s_nop 3
v_writelane_b32 v24, s45, 9
v_readlane_b32 s46, v170, 63
s_nop 3
v_writelane_b32 v24, s46, 10
v_readlane_b32 s47, v171, 63
s_nop 3
v_writelane_b32 v24, s47, 11
v_readlane_b32 s44, v172, 63
s_nop 3
v_writelane_b32 v24, s44, 12
v_readlane_b32 s45, v173, 63
s_nop 3
v_writelane_b32 v24, s45, 13
v_readlane_b32 s46, v174, 63
s_nop 3
v_writelane_b32 v24, s46, 14
v_readlane_b32 s47, v175, 63
s_nop 3
v_writelane_b32 v24, s47, 15
v_cvt_pk_bf16_f32 v24, v24, v24
v_and_b32 v24, s31, v24
v_mul_f32 v24, 0xbfb8aa3b, v24
v_exp_f32 v24, v24
s_nop 0
v_add_f32 v24, 1.0, v24
v_rcp_f32 v24, v24
s_nop 0
v_cvt_pk_bf16_f32 v24, v24, v24
v_and_b32 v24, s31, v24
s_lshl_b32 s13, s12, 2
s_add_u32 s13, s13, 12582912
s_add_u32 s20, s4, s13
s_addc_u32 s21, s5, 0
s_and_b32 s21, s21, 0xffff
s_mov_b32 s22, 64
s_mov_b32 s23, 0x20000
v_lshlrev_b32 v25, 2, v2
buffer_store_dword v24, v25, s[20:23], 0 offen sc1
s_branch L_ka_fin
L_role_ssm:
s_load_dwordx2 s[4:5], s[0:1], 120
s_load_dwordx2 s[6:7], s[0:1], 0
s_load_dwordx2 s[8:9], s[0:1], 8
s_load_dwordx2 s[10:11], s[0:1], 16
s_load_dwordx2 s[12:13], s[0:1], 24
s_load_dwordx2 s[14:15], s[0:1], 32
s_load_dwordx2 s[16:17], s[0:1], 40
s_load_dwordx2 s[18:19], s[0:1], 48
s_load_dwordx2 s[20:21], s[0:1], 56
s_load_dwordx2 s[22:23], s[0:1], 64
s_load_dwordx2 s[58:59], s[0:1], 112
s_load_dwordx2 s[56:57], s[0:1], 88
v_lshrrev_b32 v1, 6, v0
v_and_b32 v2, 63, v0
s_sub_u32 s24, s2, 256
v_readfirstlane_b32 s25, v1
s_and_b32 s26, s24, 7
s_lshr_b32 s27, s24, 3
s_lshl_b32 s26, s26, 6
s_lshl_b32 s27, s27, 1
s_add_u32 s26, s26, s27
s_lshr_b32 s27, s25, 1
s_and_b32 s28, s25, 1
s_add_u32 s29, s26, s27
s_lshl_b32 s30, s29, 8
s_lshl_b32 s31, s28, 7
s_add_u32 s30, s30, s31
v_lshlrev_b32 v3, 1, v2
v_add_u32 v3, s30, v3
s_lshl_b32 s31, s26, 1
s_waitcnt lgkmcnt(0)
s_add_u32 s20, s20, s31
s_addc_u32 s21, s21, 0
s_add_u32 s22, s22, s31
s_addc_u32 s23, s23, 0
s_load_dword s32, s[20:21], 0
s_load_dword s33, s[22:23], 0
s_and_b32 s34, s24, 7
s_lshr_b32 s35, s24, 3
s_and_b32 s48, s34, 1
s_lshr_b32 s34, s34, 1
s_lshl_b32 s34, s34, 3
s_and_b32 s47, s35, 7
s_add_u32 s34, s34, s47
s_lshr_b32 s35, s35, 3
s_lshl_b32 s48, s48, 2
s_add_u32 s35, s35, s48
s_lshl_b32 s47, s34, 16
s_lshl_b32 s48, s25, 14
s_add_u32 s47, s47, s48
s_lshl_b32 s48, s35, 7
s_add_u32 s47, s47, s48
s_add_u32 s40, s6, s47
s_addc_u32 s41, s7, 0
s_and_b32 s41, s41, 0xffff
s_mov_b32 s42, 15488
s_mov_b32 s43, 0x20000
v_lshrrev_b32 v4, 3, v2
v_lshlrev_b32 v4, 10, v4
v_and_b32 v5, 7, v2
v_lshlrev_b32 v5, 4, v5
v_add_u32 v4, v4, v5
s_lshl_b32 s48, s25, 11
s_add_u32 s48, s48, 59904
s_mov_b32 m0, s48
s_mov_b32 s49, 7168
buffer_load_dwordx4 v4, s[40:43], 0 offen lds
buffer_load_dwordx4 v4, s[40:43], s49 offen offset:1024 lds
s_mov_b32 s36, s8
s_and_b32 s37, s9, 0xffff
s_mov_b32 s38, 131072
s_mov_b32 s39, 0x20000
buffer_load_ushort v8, v3, s[36:39], 0 offen
s_mov_b32 s36, s10
s_and_b32 s37, s11, 0xffff
s_mov_b32 s38, 131072
s_mov_b32 s39, 0x20000
buffer_load_ushort v9, v3, s[36:39], 0 offen
s_mov_b32 s36, s12
s_and_b32 s37, s13, 0xffff
s_mov_b32 s38, 131072
s_mov_b32 s39, 0x20000
buffer_load_ushort v10, v3, s[36:39], 0 offen
s_mov_b32 s36, s14
s_and_b32 s37, s15, 0xffff
s_mov_b32 s38, 131072
s_mov_b32 s39, 0x20000
buffer_load_ushort v11, v3, s[36:39], 0 offen
s_mov_b32 s36, s16
s_and_b32 s37, s17, 0xffff
s_mov_b32 s38, 131072
s_mov_b32 s39, 0x20000
buffer_load_ushort v12, v3, s[36:39], 0 offen
s_mov_b32 s36, s18
s_and_b32 s37, s19, 0xffff
s_mov_b32 s38, 131072
s_mov_b32 s39, 0x20000
buffer_load_ushort v13, v3, s[36:39], 0 offen
v_and_b32 v6, 127, v0
v_lshlrev_b32 v6, 1, v6
v_lshrrev_b32 v7, 7, v0
v_mul_u32_u24 v7, 4224, v7
v_add_u32 v7, 43264, v7
s_mov_b32 s46, 0xffff0000
v_add_u32 v216, 0, v6
v_cvt_f32_u32 v216, v216
v_cvt_pk_bf16_f32 v216, v216, v216
v_and_b32 v216, s46, v216
v_cvt_u32_f32 v216, v216
v_lshl_add_u32 v216, v216, 1, v7
v_add_u32 v217, 1, v6
v_cvt_f32_u32 v217, v217
v_cvt_pk_bf16_f32 v217, v217, v217
v_and_b32 v217, s46, v217
v_cvt_u32_f32 v217, v217
v_lshl_add_u32 v217, v217, 1, v7
v_add_u32 v218, 256, v6
v_cvt_f32_u32 v218, v218
v_cvt_pk_bf16_f32 v218, v218, v218
v_and_b32 v218, s46, v218
v_cvt_u32_f32 v218, v218
v_lshl_add_u32 v218, v218, 1, v7
v_add_u32 v219, 257, v6
v_cvt_f32_u32 v219, v219
v_cvt_pk_bf16_f32 v219, v219, v219
v_and_b32 v219, s46, v219
v_cvt_u32_f32 v219, v219
v_lshl_add_u32 v219, v219, 1, v7
v_add_u32 v220, 512, v6
v_cvt_f32_u32 v220, v220
v_cvt_pk_bf16_f32 v220, v220, v220
v_and_b32 v220, s46, v220
v_cvt_u32_f32 v220, v220
v_lshl_add_u32 v220, v220, 1, v7
v_add_u32 v221, 513, v6
v_cvt_f32_u32 v221, v221
v_cvt_pk_bf16_f32 v221, v221, v221
v_and_b32 v221, s46, v221
v_cvt_u32_f32 v221, v221
v_lshl_add_u32 v221, v221, 1, v7
v_add_u32 v222, 768, v6
v_cvt_f32_u32 v222, v222
v_cvt_pk_bf16_f32 v222, v222, v222
v_and_b32 v222, s46, v222
v_cvt_u32_f32 v222, v222
v_lshl_add_u32 v222, v222, 1, v7
v_add_u32 v223, 769, v6
v_cvt_f32_u32 v223, v223
v_cvt_pk_bf16_f32 v223, v223, v223
v_and_b32 v223, s46, v223
v_cvt_u32_f32 v223, v223
v_lshl_add_u32 v223, v223, 1, v7
v_add_u32 v224, 1024, v6
v_cvt_f32_u32 v224, v224
v_cvt_pk_bf16_f32 v224, v224, v224
v_and_b32 v224, s46, v224
v_cvt_u32_f32 v224, v224
v_lshl_add_u32 v224, v224, 1, v7
v_add_u32 v225, 1025, v6
v_cvt_f32_u32 v225, v225
v_cvt_pk_bf16_f32 v225, v225, v225
v_and_b32 v225, s46, v225
v_cvt_u32_f32 v225, v225
v_lshl_add_u32 v225, v225, 1, v7
v_add_u32 v226, 1280, v6
v_cvt_f32_u32 v226, v226
v_cvt_pk_bf16_f32 v226, v226, v226
v_and_b32 v226, s46, v226
v_cvt_u32_f32 v226, v226
v_lshl_add_u32 v226, v226, 1, v7
v_add_u32 v227, 1281, v6
v_cvt_f32_u32 v227, v227
v_cvt_pk_bf16_f32 v227, v227, v227
v_and_b32 v227, s46, v227
v_cvt_u32_f32 v227, v227
v_lshl_add_u32 v227, v227, 1, v7
v_add_u32 v228, 1536, v6
v_cvt_f32_u32 v228, v228
v_cvt_pk_bf16_f32 v228, v228, v228
v_and_b32 v228, s46, v228
v_cvt_u32_f32 v228, v228
v_lshl_add_u32 v228, v228, 1, v7
v_add_u32 v229, 1537, v6
v_cvt_f32_u32 v229, v229
v_cvt_pk_bf16_f32 v229, v229, v229
v_and_b32 v229, s46, v229
v_cvt_u32_f32 v229, v229
v_lshl_add_u32 v229, v229, 1, v7
v_add_u32 v230, 1792, v6
v_cvt_f32_u32 v230, v230
v_cvt_pk_bf16_f32 v230, v230, v230
v_and_b32 v230, s46, v230
v_cvt_u32_f32 v230, v230
v_lshl_add_u32 v230, v230, 1, v7
v_add_u32 v231, 1793, v6
v_cvt_f32_u32 v231, v231
v_cvt_pk_bf16_f32 v231, v231, v231
v_and_b32 v231, s46, v231
v_cvt_u32_f32 v231, v231
v_lshl_add_u32 v231, v231, 1, v7
v_mov_b32 v232, 0
v_mov_b32 v233, 0
v_mov_b32 v234, 0
v_mov_b32 v235, 0
v_lshrrev_b32 v14, 5, v0
v_mul_u32_u24 v14, 4608, v14
v_and_b32 v15, 31, v0
v_lshlrev_b32 v15, 4, v15
v_add_u32 v14, v14, v15
v_add_u32 v14, 34048, v14
v_subrev_u32 v15, 64, v0
v_lshrrev_b32 v16, 3, v15
v_mul_u32_u24 v16, 16640, v16
v_lshrrev_b32 v17, 1, v15
v_and_b32 v17, 3, v17
v_mul_u32_u24 v17, 4160, v17
v_add_u32 v16, v16, v17
v_and_b32 v17, 1, v15
v_lshlrev_b32 v17, 4, v17
v_add_u32 v16, v16, v17
v_add_u32 v16, 4608, v16
v_cmp_gt_u32 vcc, 64, v0
s_nop 1
v_cndmask_b32 v14, v16, v14, vcc
v_cmp_gt_u32 vcc, 80, v0
s_and_saveexec_b64 s[44:45], vcc
s_cbranch_execz L_pz_2
ds_write_b128 v14, v[232:235]
L_pz_2:
s_mov_b64 exec, s[44:45]
v_lshrrev_b32 v14, 4, v2
v_lshlrev_b32 v15, 10, v14
v_lshrrev_b32 v16, 2, v2
v_and_b32 v16, 3, v16
v_lshlrev_b32 v16, 7, v16
v_add_u32 v15, v15, v16
v_and_b32 v16, 3, v2
v_lshlrev_b32 v16, 3, v16
v_add_u32 v15, v15, v16
s_lshl_b32 s48, s25, 5
s_add_u32 s48, s48, 59904
v_add_u32 v15, s48, v15
v_and_b32 v16, 15, v2
v_lshlrev_b32 v16, 12, v16
v_lshlrev_b32 v14, 4, v14
v_add_u32 v16, v16, v14
s_lshl_b32 s47, s35, 18
s_lshl_b32 s48, s25, 16
s_add_u32 s47, s47, s48
s_lshl_b32 s48, s34, 7
s_add_u32 s47, s47, s48
s_add_u32 s47, s47, 16777216
s_add_u32 s40, s4, s47
s_addc_u32 s41, s5, 0
s_and_b32 s41, s41, 0xffff
s_mov_b32 s42, 65536
s_mov_b32 s43, 0x20000
s_mov_b32 s60, s58
s_and_b32 s61, s59, 0xffff
s_mov_b32 s62, 256
s_mov_b32 s63, 0x20000
s_waitcnt vmcnt(6)
s_barrier
ds_read_b64_tr_b16 v[184:185], v15 offset:0
ds_read_b64_tr_b16 v[186:187], v15 offset:512
ds_read_b64_tr_b16 v[188:189], v15 offset:4096
ds_read_b64_tr_b16 v[190:191], v15 offset:4608
s_waitcnt lgkmcnt(0)
buffer_store_dwordx4 v[184:187], v16, s[40:43], 0 offen offset:0 sc1
buffer_store_dwordx4 v[188:191], v16, s[40:43], 0 offen offset:64 sc1
s_waitcnt lgkmcnt(0)
s_lshl_b32 s47, s27, 4
s_lshr_b32 s32, s32, s47
s_lshl_b32 s32, s32, 16
s_lshr_b32 s33, s33, s47
s_lshl_b32 s33, s33, 16
v_mov_b32 v14, s32
v_mul_f32 v14, 0x3fb8aa3b, v14
v_exp_f32 v14, v14
s_nop 0
v_cvt_pk_bf16_f32 v14, v14, v14
v_and_b32 v14, s46, v14
s_waitcnt vmcnt(2)
v_lshlrev_b32 v8, 16, v8
v_lshlrev_b32 v9, 16, v9
v_lshlrev_b32 v10, 16, v10
v_lshlrev_b32 v11, 16, v11
v_lshlrev_b32 v12, 16, v12
v_lshlrev_b32 v13, 16, v13
v_mul_f32 v20, v14, v8
v_mul_f32 v21, v14, v9
v_mul_f32 v20, 0x3fb8aa3b, v20
v_mul_f32 v21, 0x3e22f983, v21
v_mul_f32 v10, v14, v10
v_mul_f32 v11, v14, v11
v_mul_f32 v16, v13, v11
v_mul_f32 v17, v13, v10
v_fma_f32 v22, v12, v10, -v16
v_fma_f32 v23, v12, v11, v17
s_mov_b32 s48, 0x44000000
s_mov_b32 s49, 0x45000000
v_mul_f32 v16, s48, v20
v_mul_f32 v17, s48, v21
v_exp_f32 v16, v16
v_fract_f32 v17, v17
v_cos_f32 v24, v17
v_sin_f32 v25, v17
s_nop 0
v_mul_f32 v24, v24, v16
v_mul_f32 v25, v25, v16
v_mul_f32 v16, 4.0, v20
v_mul_f32 v17, 4.0, v21
v_exp_f32 v16, v16
v_fract_f32 v17, v17
v_cos_f32 v26, v17
v_sin_f32 v27, v17
s_nop 0
v_mul_f32 v26, v26, v16
v_mul_f32 v27, v27, v16
v_mul_f32 v16, s49, v20
v_mul_f32 v17, s49, v21
v_exp_f32 v16, v16
v_fract_f32 v17, v17
v_cos_f32 v28, v17
v_sin_f32 v29, v17
s_nop 0
v_mul_f32 v28, v28, v16
v_mul_f32 v29, v29, v16
v_mul_f32 v28, v28, v22
v_fma_f32 v28, -v29, v23, v28
s_lshl_b32 s50, s27, 12
s_lshl_b32 s51, s28, 11
s_add_u32 s50, s50, s51
s_add_u32 s50, s50, 51712
v_lshlrev_b32 v15, 5, v2
v_add_u32 v15, s50, v15
ds_write_b128 v15, v[20:23]
ds_write_b128 v15, v[24:27] offset:16
s_nop 1
v_add_f32_dpp v28, v28, v28 row_shr:1 row_mask:0xf bank_mask:0xf bound_ctrl:0
s_nop 1
v_add_f32_dpp v28, v28, v28 row_shr:2 row_mask:0xf bank_mask:0xf bound_ctrl:0
s_nop 1
v_add_f32_dpp v28, v28, v28 row_shr:4 row_mask:0xf bank_mask:0xf bound_ctrl:0
s_nop 1
v_add_f32_dpp v28, v28, v28 row_shr:8 row_mask:0xf bank_mask:0xf bound_ctrl:0
s_nop 1
v_add_f32_dpp v28, v28, v28 row_bcast:15 row_mask:0xa bank_mask:0xf
s_nop 1
v_add_f32_dpp v28, v28, v28 row_bcast:31 row_mask:0xc bank_mask:0xf
s_lshl_b32 s51, s25, 2
s_add_u32 s51, s51, 76288
v_mov_b32 v29, s51
s_mov_b64 s[44:45], exec
s_mov_b32 exec_lo, 0
s_mov_b32 exec_hi, 0x80000000
ds_write_b32 v29, v28
s_mov_b64 exec, s[44:45]
v_and_b32 v16, 15, v2
v_lshrrev_b32 v17, 4, v2
v_lshrrev_b32 v18, 2, v16
v_lshlrev_b32 v18, 3, v18
v_and_b32 v19, 3, v16
v_add_u32 v18, v18, v19
v_cvt_f32_u32 v18, v18
v_lshlrev_b32 v19, 5, v16
v_cvt_f32_u32 v19, v19
v_lshlrev_b32 v15, 7, v17
v_add_u32 v15, s50, v15
v_mov_b32 v96, 0
v_mov_b32 v97, 0
v_mov_b32 v98, 0
v_mov_b32 v99, 0
v_mov_b32 v100, 0
v_mov_b32 v101, 0
v_mov_b32 v102, 0
v_mov_b32 v103, 0
v_mov_b32 v104, 0
v_mov_b32 v105, 0
v_mov_b32 v106, 0
v_mov_b32 v107, 0
v_mov_b32 v108, 0
v_mov_b32 v109, 0
v_mov_b32 v110, 0
v_mov_b32 v111, 0
v_mov_b32 v112, 0
v_mov_b32 v113, 0
v_mov_b32 v114, 0
v_mov_b32 v115, 0
v_mov_b32 v116, 0
v_mov_b32 v117, 0
v_mov_b32 v118, 0
v_mov_b32 v119, 0
v_mov_b32 v120, 0
v_mov_b32 v121, 0
v_mov_b32 v122, 0
v_mov_b32 v123, 0
v_mov_b32 v124, 0
v_mov_b32 v125, 0
v_mov_b32 v126, 0
v_mov_b32 v127, 0
s_waitcnt lgkmcnt(0)
ds_read_b128 v[32:35], v15 offset:0
ds_read_b128 v[40:43], v15 offset:32
ds_read_b128 v[48:51], v15 offset:64
ds_read_b128 v[56:59], v15 offset:96
ds_read_b128 v[36:39], v15 offset:16
ds_read_b128 v[44:47], v15 offset:48
ds_read_b128 v[52:55], v15 offset:80
ds_read_b128 v[60:63], v15 offset:112
s_and_b32 s48, s24, 7
s_and_b32 s47, s48, 3
s_lshl_b32 s47, s47, 6
s_lshr_b32 s49, s48, 2
s_lshl_b32 s49, s49, 2
s_add_u32 s47, s47, s49
s_add_u32 s47, s47, 0
v_mov_b32 v192, s47
s_mov_b32 s47, 0
L_kgen_3:
s_cmp_lg_u32 s47, 1
s_cbranch_scc1 L_nosig_4
s_waitcnt vmcnt(0)
s_barrier
s_cmp_lg_u32 s25, 0
s_cbranch_scc1 L_sig_5
s_and_b32 s48, s35, 3
s_lshl_b32 s48, s48, 6
s_lshr_b32 s49, s35, 2
s_lshl_b32 s49, s49, 2
s_add_u32 s48, s48, s49
s_add_u32 s48, s48, 0
v_mov_b32 v194, s48
v_mov_b32 v195, 1
s_mov_b64 s[44:45], exec
s_mov_b64 exec, 1
buffer_atomic_add v195, v194, s[60:63], 0 offen sc1
s_mov_b64 exec, s[44:45]
L_sig_5:
L_nosig_4:
s_cmp_lg_u32 s47, 3
s_cbranch_scc1 L_nopoll_6
buffer_load_dword v193, v192, s[60:63], 0 offen sc1
L_nopoll_6:
v_add_u32 v15, 512, v15
s_waitcnt lgkmcnt(4)
v_mul_f32 v144, v18, v32
v_mul_f32 v145, v18, v33
v_mul_f32 v160, v19, v32
v_mul_f32 v161, v19, v33
v_mul_f32 v146, v18, v40
v_mul_f32 v147, v18, v41
v_mul_f32 v162, v19, v40
v_mul_f32 v163, v19, v41
v_mul_f32 v148, v18, v48
v_mul_f32 v149, v18, v49
v_mul_f32 v164, v19, v48
v_mul_f32 v165, v19, v49
v_mul_f32 v150, v18, v56
v_mul_f32 v151, v18, v57
v_mul_f32 v166, v19, v56
v_mul_f32 v167, v19, v57
v_fract_f32 v145, v145
v_fract_f32 v147, v147
v_fract_f32 v149, v149
v_fract_f32 v151, v151
v_fract_f32 v161, v161
v_fract_f32 v163, v163
v_fract_f32 v165, v165
v_fract_f32 v167, v167
v_exp_f32 v160, v160
v_cos_f32 v136, v161
v_sin_f32 v137, v161
v_exp_f32 v162, v162
v_cos_f32 v138, v163
v_sin_f32 v139, v163
v_exp_f32 v164, v164
v_cos_f32 v140, v165
v_sin_f32 v141, v165
v_exp_f32 v166, v166
v_cos_f32 v142, v167
v_sin_f32 v143, v167
v_exp_f32 v144, v144
v_cos_f32 v128, v145
v_sin_f32 v129, v145
v_exp_f32 v146, v146
v_cos_f32 v130, v147
v_sin_f32 v131, v147
v_exp_f32 v148, v148
v_cos_f32 v132, v149
v_sin_f32 v133, v149
v_exp_f32 v150, v150
v_cos_f32 v134, v151
v_sin_f32 v135, v151
v_mul_f32 v136, v136, v160
v_mul_f32 v137, v137, v160
v_mul_f32 v138, v138, v162
v_mul_f32 v139, v139, v162
v_mul_f32 v140, v140, v164
v_mul_f32 v141, v141, v164
v_mul_f32 v142, v142, v166
v_mul_f32 v143, v143, v166
v_mul_f32 v128, v128, v144
v_mul_f32 v129, v129, v144
v_mul_f32 v130, v130, v146
v_mul_f32 v131, v131, v146
v_mul_f32 v132, v132, v148
v_mul_f32 v133, v133, v148
v_mul_f32 v134, v134, v150
v_mul_f32 v135, v135, v150
v_mul_f32 v176, v137, v35
v_mul_f32 v177, v137, v34
v_mul_f32 v178, v139, v43
v_mul_f32 v179, v139, v42
v_mul_f32 v180, v141, v51
v_mul_f32 v181, v141, v50
v_mul_f32 v182, v143, v59
v_mul_f32 v183, v143, v58
v_fma_f32 v160, v136, v34, -v176
v_fma_f32 v161, v136, v35, v177
v_fma_f32 v162, v138, v42, -v178
v_fma_f32 v163, v138, v43, v179
v_fma_f32 v164, v140, v50, -v180
v_fma_f32 v165, v140, v51, v181
v_fma_f32 v166, v142, v58, -v182
v_fma_f32 v167, v142, v59, v183
ds_read_b128 v[32:35], v15 offset:0
ds_read_b128 v[40:43], v15 offset:32
ds_read_b128 v[48:51], v15 offset:64
ds_read_b128 v[56:59], v15 offset:96
s_waitcnt lgkmcnt(4)
v_cvt_pk_bf16_f32 v64, v128, v129
v_cvt_pk_bf16_f32 v65, v130, v131
v_cvt_pk_bf16_f32 v66, v132, v133
v_cvt_pk_bf16_f32 v67, v134, v135
v_mul_f32 v176, v129, v39
v_mul_f32 v177, v129, v38
v_mul_f32 v178, v131, v47
v_mul_f32 v179, v131, v46
v_mul_f32 v180, v133, v55
v_mul_f32 v181, v133, v54
v_mul_f32 v182, v135, v63
v_mul_f32 v183, v135, v62
v_fma_f32 v144, v128, v38, -v176
v_fma_f32 v145, v128, v39, v177
v_fma_f32 v146, v130, v46, -v178
v_fma_f32 v147, v130, v47, v179
v_fma_f32 v148, v132, v54, -v180
v_fma_f32 v149, v132, v55, v181
v_fma_f32 v150, v134, v62, -v182
v_fma_f32 v151, v134, v63, v183
v_cvt_pk_bf16_f32 v68, v144, v145
v_cvt_pk_bf16_f32 v69, v146, v147
v_cvt_pk_bf16_f32 v70, v148, v149
v_cvt_pk_bf16_f32 v71, v150, v151
v_cvt_pk_bf16_f32 v72, v160, -v161
v_cvt_pk_bf16_f32 v73, v162, -v163
v_cvt_pk_bf16_f32 v74, v164, -v165
v_cvt_pk_bf16_f32 v75, v166, -v167
v_mul_f32 v176, v161, v37
v_mul_f32 v177, v161, v36
v_mul_f32 v178, v163, v45
v_mul_f32 v179, v163, v44
v_mul_f32 v180, v165, v53
v_mul_f32 v181, v165, v52
v_mul_f32 v182, v167, v61
v_mul_f32 v183, v167, v60
v_fma_f32 v136, v160, v36, -v176
v_fma_f32 v137, v160, v37, v177
v_fma_f32 v138, v162, v44, -v178
v_fma_f32 v139, v162, v45, v179
v_fma_f32 v140, v164, v52, -v180
v_fma_f32 v141, v164, v53, v181
v_fma_f32 v142, v166, v60, -v182
v_fma_f32 v143, v166, v61, v183
v_cvt_pk_bf16_f32 v76, v136, -v137
v_cvt_pk_bf16_f32 v77, v138, -v139
v_cvt_pk_bf16_f32 v78, v140, -v141
v_cvt_pk_bf16_f32 v79, v142, -v143
v_mul_f32 v176, v137, v37
v_mul_f32 v177, v137, v36
v_mul_f32 v178, v139, v45
v_mul_f32 v179, v139, v44
v_mul_f32 v180, v141, v53
v_mul_f32 v181, v141, v52
v_mul_f32 v182, v143, v61
v_mul_f32 v183, v143, v60
v_fma_f32 v160, v136, v36, -v176
v_fma_f32 v161, v136, v37, v177
v_fma_f32 v162, v138, v44, -v178
v_fma_f32 v163, v138, v45, v179
v_fma_f32 v164, v140, v52, -v180
v_fma_f32 v165, v140, v53, v181
v_fma_f32 v166, v142, v60, -v182
v_fma_f32 v167, v142, v61, v183
v_cvt_pk_bf16_f32 v80, v160, -v161
v_cvt_pk_bf16_f32 v81, v162, -v163
v_cvt_pk_bf16_f32 v82, v164, -v165
v_cvt_pk_bf16_f32 v83, v166, -v167
v_mul_f32 v176, v161, v37
v_mul_f32 v177, v161, v36
v_mul_f32 v178, v163, v45
v_mul_f32 v179, v163, v44
v_mul_f32 v180, v165, v53
v_mul_f32 v181, v165, v52
v_mul_f32 v182, v167, v61
v_mul_f32 v183, v167, v60
v_fma_f32 v136, v160, v36, -v176
v_fma_f32 v137, v160, v37, v177
v_fma_f32 v138, v162, v44, -v178
v_fma_f32 v139, v162, v45, v179
v_fma_f32 v140, v164, v52, -v180
v_fma_f32 v141, v164, v53, v181
v_fma_f32 v142, v166, v60, -v182
v_fma_f32 v143, v166, v61, v183
ds_read_b128 v[36:39], v15 offset:16
ds_read_b128 v[44:47], v15 offset:48
ds_read_b128 v[52:55], v15 offset:80
ds_read_b128 v[60:63], v15 offset:112
v_cvt_pk_bf16_f32 v84, v136, -v137
v_cvt_pk_bf16_f32 v85, v138, -v139
v_cvt_pk_bf16_f32 v86, v140, -v141
v_cvt_pk_bf16_f32 v87, v142, -v143
s_nop 1
v_mfma_f32_16x16x32_bf16 v[96:99], v[64:67], v[72:75], v[96:99]
v_mfma_f32_16x16x32_bf16 v[100:103], v[64:67], v[76:79], v[100:103]
v_mfma_f32_16x16x32_bf16 v[104:107], v[64:67], v[80:83], v[104:107]
v_mfma_f32_16x16x32_bf16 v[108:111], v[64:67], v[84:87], v[108:111]
v_mfma_f32_16x16x32_bf16 v[112:115], v[68:71], v[72:75], v[112:115]
v_mfma_f32_16x16x32_bf16 v[116:119], v[68:71], v[76:79], v[116:119]
v_mfma_f32_16x16x32_bf16 v[120:123], v[68:71], v[80:83], v[120:123]
v_mfma_f32_16x16x32_bf16 v[124:127], v[68:71], v[84:87], v[124:127]
s_add_u32 s47, s47, 1
s_cmp_lt_u32 s47, 4
s_cbranch_scc1 L_kgen_3
s_mov_b32 s53, 0
L_poll_7:
s_waitcnt vmcnt(0)
v_readfirstlane_b32 s47, v193
s_cmp_ge_u32 s47, 32
s_cbranch_scc1 L_polled_8
s_add_u32 s53, s53, 1
s_cmp_ge_u32 s53, 0x40000
s_cbranch_scc1 L_polled_8
s_sleep 8
buffer_load_dword v193, v192, s[60:63], 0 offen sc1
s_branch L_poll_7
L_polled_8:
s_lshl_b32 s47, s29, 12
s_add_u32 s47, s47, 16777216
s_add_u32 s40, s4, s47
s_addc_u32 s41, s5, 0
s_and_b32 s41, s41, 0xffff
s_mov_b32 s42, 4096
s_mov_b32 s43, 0x20000
v_and_b32 v192, 127, v0
v_lshlrev_b32 v192, 5, v192
v_subrev_u32 v193, 8, v192
v_max_i32 v193, 0, v193
buffer_load_dwordx4 v[200:203], v192, s[40:43], 0 offen sc1
buffer_load_dwordx4 v[204:207], v192, s[40:43], 0 offen offset:16 sc1
buffer_load_dwordx2 v[208:209], v193, s[40:43], 0 offen sc1
s_nop 7
v_lshlrev_b32 v14, 4, v2
s_lshl_b32 s54, s25, 12
s_add_u32 s54, s54, 59904
v_add_u32 v15, s54, v14
s_xor_b32 s55, s25, 1
s_lshl_b32 s55, s55, 12
s_add_u32 s55, s55, 59904
v_add_u32 v16, s55, v14
s_cmp_eq_u32 s28, 1
s_cbranch_scc1 L_h1_9
ds_write_b128 v15, v[104:107] offset:0
ds_write_b128 v15, v[108:111] offset:1024
ds_write_b128 v15, v[120:123] offset:2048
ds_write_b128 v15, v[124:127] offset:3072
s_branch L_hd_10
L_h1_9:
ds_write_b128 v15, v[96:99] offset:0
ds_write_b128 v15, v[100:103] offset:1024
ds_write_b128 v15, v[112:115] offset:2048
ds_write_b128 v15, v[116:119] offset:3072
L_hd_10:
s_waitcnt lgkmcnt(0)
s_barrier
ds_read_b128 v[80:83], v16 offset:0
ds_read_b128 v[84:87], v16 offset:1024
ds_read_b128 v[88:91], v16 offset:2048
ds_read_b128 v[92:95], v16 offset:3072
s_lshl_b32 s51, s27, 3
s_add_u32 s51, s51, 76288
v_mov_b32 v29, s51
ds_read_b64 v[30:31], v29
s_waitcnt lgkmcnt(0)
s_cmp_eq_u32 s28, 1
s_cbranch_scc1 L_fh2_11
v_add_f32 v64, v96, v80
v_add_f32 v65, v97, v81
v_add_f32 v66, v98, v82
v_add_f32 v67, v99, v83
v_add_f32 v68, v100, v84
v_add_f32 v69, v101, v85
v_add_f32 v70, v102, v86
v_add_f32 v71, v103, v87
v_add_f32 v72, v112, v88
v_add_f32 v73, v113, v89
v_add_f32 v74, v114, v90
v_add_f32 v75, v115, v91
v_add_f32 v76, v116, v92
v_add_f32 v77, v117, v93
v_add_f32 v78, v118, v94
v_add_f32 v79, v119, v95
s_branch L_fhe_12
L_fh2_11:
v_add_f32 v64, v104, v80
v_add_f32 v65, v105, v81
v_add_f32 v66, v106, v82
v_add_f32 v67, v107, v83
v_add_f32 v68, v108, v84
v_add_f32 v69, v109, v85
v_add_f32 v70, v110, v86
v_add_f32 v71, v111, v87
v_add_f32 v72, v120, v88
v_add_f32 v73, v121, v89
v_add_f32 v74, v122, v90
v_add_f32 v75, v123, v91
v_add_f32 v76, v124, v92
v_add_f32 v77, v125, v93
v_add_f32 v78, v126, v94
v_add_f32 v79, v127, v95
L_fhe_12:
v_and_b32 v16, 15, v2
v_lshlrev_b32 v16, 6, v16
v_lshrrev_b32 v17, 4, v2
v_lshlrev_b32 v17, 4, v17
v_add_u32 v16, v16, v17
s_mul_i32 s56, s27, 4224
s_lshl_b32 s57, s28, 11
s_add_u32 s57, s57, s56
s_add_u32 s57, s57, 43264
v_add_u32 v16, s57, v16
v_cvt_pk_bf16_f32 v32, v64, v65
v_cvt_pk_bf16_f32 v33, v66, v67
v_cvt_pk_bf16_f32 v34, v72, v73
v_cvt_pk_bf16_f32 v35, v74, v75
ds_write_b128 v16, v[32:35] offset:0
v_cvt_pk_bf16_f32 v36, v68, v69
v_cvt_pk_bf16_f32 v37, v70, v71
v_cvt_pk_bf16_f32 v38, v76, v77
v_cvt_pk_bf16_f32 v39, v78, v79
ds_write_b128 v16, v[36:39] offset:1024
v_add_f32 v30, v30, v31
v_cvt_pk_bf16_f32 v30, v30, v30
s_add_u32 s56, s56, 47360
v_mov_b32 v29, s56
s_mov_b64 s[44:45], exec
s_mov_b64 exec, 1
ds_write_b16 v29, v30
s_mov_b64 exec, s[44:45]
s_waitcnt vmcnt(0)
v_and_b32 v14, 127, v0
v_cmp_eq_u32 vcc, 0, v14
s_mov_b32 s52, 0xffff
v_mov_b32 v20, 0
v_cndmask_b32 v208, v208, v20, vcc
v_cndmask_b32 v209, v209, v20, vcc
v_sub_u32 v14, 127, v14
v_lshlrev_b32 v14, 5, v14
s_mul_i32 s53, s27, 16640
v_add_u32 v14, s53, v14
v_alignbit_b32 v128, v203, v203, 16
v_alignbit_b32 v129, v202, v202, 16
v_alignbit_b32 v130, v201, v201, 16
v_alignbit_b32 v131, v200, v200, 16
ds_write_b128 v14, v[128:131] offset:528
v_alignbit_b32 v132, v207, v207, 16
v_alignbit_b32 v133, v206, v206, 16
v_alignbit_b32 v134, v205, v205, 16
v_alignbit_b32 v135, v204, v204, 16
ds_write_b128 v14, v[132:135] offset:512
v_bfi_b32 v136, s52, v203, v202
v_bfi_b32 v137, s52, v202, v201
v_bfi_b32 v138, s52, v201, v200
v_bfi_b32 v139, s52, v200, v209
ds_write_b128 v14, v[136:139] offset:4688
v_bfi_b32 v140, s52, v207, v206
v_bfi_b32 v141, s52, v206, v205
v_bfi_b32 v142, s52, v205, v204
v_bfi_b32 v143, s52, v204, v203
ds_write_b128 v14, v[140:143] offset:4672
v_alignbit_b32 v144, v202, v202, 16
v_alignbit_b32 v145, v201, v201, 16
v_alignbit_b32 v146, v200, v200, 16
v_alignbit_b32 v147, v209, v209, 16
ds_write_b128 v14, v[144:147] offset:8848
v_alignbit_b32 v148, v206, v206, 16
v_alignbit_b32 v149, v205, v205, 16
v_alignbit_b32 v150, v204, v204, 16
v_alignbit_b32 v151, v203, v203, 16
ds_write_b128 v14, v[148:151] offset:8832
v_bfi_b32 v152, s52, v202, v201
v_bfi_b32 v153, s52, v201, v200
v_bfi_b32 v154, s52, v200, v209
v_bfi_b32 v155, s52, v209, v208
ds_write_b128 v14, v[152:155] offset:13008
v_bfi_b32 v156, s52, v206, v205
v_bfi_b32 v157, s52, v205, v204
v_bfi_b32 v158, s52, v204, v203
v_bfi_b32 v159, s52, v203, v202
ds_write_b128 v14, v[156:159] offset:12992
s_waitcnt lgkmcnt(0)
s_barrier
ds_read_u16 v32, v216
ds_read_u16_d16_hi v40, v217
ds_read_u16 v33, v218
ds_read_u16_d16_hi v41, v219
ds_read_u16 v34, v220
ds_read_u16_d16_hi v42, v221
ds_read_u16 v35, v222
ds_read_u16_d16_hi v43, v223
ds_read_u16 v36, v224
ds_read_u16_d16_hi v44, v225
ds_read_u16 v37, v226
ds_read_u16_d16_hi v45, v227
v_and_b32 v16, 127, v0
v_lshlrev_b32 v16, 2, v16
v_lshrrev_b32 v17, 7, v0
v_mul_u32_u24 v17, 4608, v17
v_add_u32 v16, v16, v17
s_waitcnt lgkmcnt(6)
ds_read_u16 v38, v228
ds_read_u16_d16_hi v46, v229
ds_read_u16 v39, v230
ds_read_u16_d16_hi v47, v231
v_or_b32 v32, v32, v40
ds_write_b32 v16, v32 offset:34560
v_or_b32 v33, v33, v41
ds_write_b32 v16, v33 offset:35072
v_or_b32 v34, v34, v42
ds_write_b32 v16, v34 offset:35584
s_waitcnt lgkmcnt(7)
v_or_b32 v35, v35, v43
ds_write_b32 v16, v35 offset:36096
v_or_b32 v36, v36, v44
ds_write_b32 v16, v36 offset:36608
v_or_b32 v37, v37, v45
ds_write_b32 v16, v37 offset:37120
s_waitcnt lgkmcnt(6)
v_or_b32 v38, v38, v46
ds_write_b32 v16, v38 offset:37632
v_or_b32 v39, v39, v47
ds_write_b32 v16, v39 offset:38144
v_and_b32 v16, 15, v2
v_lshrrev_b32 v17, 4, v2
v_lshlrev_b32 v18, 5, v16
v_lshlrev_b32 v19, 4, v17
v_add_u32 v18, v18, v19
s_mul_i32 s56, s27, 4608
s_lshl_b32 s57, s28, 8
s_sub_u32 s56, s56, s57
s_add_u32 s56, s56, 34336
v_add_u32 v18, s56, v18
v_and_b32 v20, 3, v16
v_sub_u32 v20, 3, v20
v_mul_u32_u24 v20, 4160, v20
v_add_u32 v20, v20, v19
v_lshrrev_b32 v21, 2, v16
v_lshlrev_b32 v21, 3, v21
v_sub_u32 v20, v20, v21
s_mul_i32 s56, s27, 16640
s_sub_u32 s56, s56, s57
s_add_u32 s56, s56, 536
v_add_u32 v19, s56, v20
v_lshlrev_b32 v20, 5, v16
v_lshlrev_b32 v21, 3, v17
v_add_u32 v20, v20, v21
s_mul_i32 s56, s27, 16640
s_lshl_b32 s57, s28, 11
s_sub_u32 s56, s56, s57
s_add_u32 s56, s56, 3064
v_sub_u32 v21, s56, v20
s_waitcnt lgkmcnt(0)
s_barrier
ds_read_b64 v[64:65], v19 offset:4032
ds_read_b64 v[66:67], v19 offset:4040
ds_read_b128 v[96:99], v18 offset:192
ds_read_b64 v[68:69], v19 offset:3520
ds_read_b64 v[70:71], v19 offset:3528
ds_read_b128 v[100:103], v18 offset:704
ds_read_b64 v[72:73], v19 offset:3008
ds_read_b64 v[74:75], v19 offset:3016
ds_read_b128 v[104:107], v18 offset:1216
ds_read_b64 v[76:77], v19 offset:2496
ds_read_b64 v[78:79], v19 offset:2504
ds_read_b128 v[108:111], v18 offset:1728
ds_read_b64 v[80:81], v19 offset:1984
ds_read_b64 v[82:83], v19 offset:1992
ds_read_b128 v[112:115], v18 offset:2240
ds_read_b64 v[84:85], v19 offset:1472
ds_read_b64 v[86:87], v19 offset:1480
ds_read_b128 v[116:119], v18 offset:2752
ds_read_b64 v[88:89], v19 offset:960
ds_read_b64 v[90:91], v19 offset:968
ds_read_b128 v[120:123], v18 offset:3264
ds_read_b64 v[92:93], v19 offset:448
ds_read_b64 v[94:95], v19 offset:456
ds_read_b128 v[124:127], v18 offset:3776
s_waitcnt lgkmcnt(0)
v_mfma_f32_16x16x32_bf16 v[32:35], v[64:67], v[96:99], 0
ds_read_b64 v[128:129], v19 offset:3968
v_mfma_f32_16x16x32_bf16 v[36:39], v[64:67], v[100:103], 0
ds_read_b64 v[130:131], v19 offset:3976
v_mfma_f32_16x16x32_bf16 v[36:39], v[68:71], v[96:99], v[36:39]
ds_read_b128 v[160:163], v18 offset:128
v_mfma_f32_16x16x32_bf16 v[40:43], v[68:71], v[100:103], 0
ds_read_b64 v[132:133], v19 offset:3456
v_mfma_f32_16x16x32_bf16 v[40:43], v[64:67], v[104:107], v[40:43]
ds_read_b64 v[134:135], v19 offset:3464
v_mfma_f32_16x16x32_bf16 v[40:43], v[72:75], v[96:99], v[40:43]
ds_read_b128 v[164:167], v18 offset:640
v_mfma_f32_16x16x32_bf16 v[44:47], v[68:71], v[104:107], 0
ds_read_b64 v[136:137], v19 offset:2944
v_mfma_f32_16x16x32_bf16 v[44:47], v[72:75], v[100:103], v[44:47]
ds_read_b64 v[138:139], v19 offset:2952
v_mfma_f32_16x16x32_bf16 v[48:51], v[72:75], v[104:107], 0
ds_read_b128 v[168:171], v18 offset:1152
v_mfma_f32_16x16x32_bf16 v[44:47], v[64:67], v[108:111], v[44:47]
ds_read_b64 v[140:141], v19 offset:2432
v_mfma_f32_16x16x32_bf16 v[44:47], v[76:79], v[96:99], v[44:47]
ds_read_b64 v[142:143], v19 offset:2440
v_mfma_f32_16x16x32_bf16 v[48:51], v[68:71], v[108:111], v[48:51]
ds_read_b128 v[172:175], v18 offset:1664
v_mfma_f32_16x16x32_bf16 v[48:51], v[76:79], v[100:103], v[48:51]
ds_read_b64 v[144:145], v19 offset:1920
v_mfma_f32_16x16x32_bf16 v[52:55], v[72:75], v[108:111], 0
ds_read_b64 v[146:147], v19 offset:1928
v_mfma_f32_16x16x32_bf16 v[52:55], v[76:79], v[104:107], v[52:55]
ds_read_b128 v[176:179], v18 offset:2176
v_mfma_f32_16x16x32_bf16 v[56:59], v[76:79], v[108:111], 0
ds_read_b64 v[148:149], v19 offset:1408
v_mfma_f32_16x16x32_bf16 v[48:51], v[64:67], v[112:115], v[48:51]
ds_read_b64 v[150:151], v19 offset:1416
v_mfma_f32_16x16x32_bf16 v[48:51], v[80:83], v[96:99], v[48:51]
ds_read_b128 v[180:183], v18 offset:2688
v_mfma_f32_16x16x32_bf16 v[52:55], v[68:71], v[112:115], v[52:55]
ds_read_b64 v[152:153], v19 offset:896
v_mfma_f32_16x16x32_bf16 v[52:55], v[80:83], v[100:103], v[52:55]
ds_read_b64 v[154:155], v19 offset:904
v_mfma_f32_16x16x32_bf16 v[56:59], v[72:75], v[112:115], v[56:59]
ds_read_b128 v[184:187], v18 offset:3200
v_mfma_f32_16x16x32_bf16 v[56:59], v[80:83], v[104:107], v[56:59]
ds_read_b64 v[156:157], v19 offset:384
v_mfma_f32_16x16x32_bf16 v[60:63], v[76:79], v[112:115], 0
ds_read_b64 v[158:159], v19 offset:392
v_mfma_f32_16x16x32_bf16 v[60:63], v[80:83], v[108:111], v[60:63]
ds_read_b128 v[188:191], v18 offset:3712
v_mfma_f32_16x16x32_bf16 v[52:55], v[64:67], v[116:119], v[52:55]
v_mfma_f32_16x16x32_bf16 v[52:55], v[84:87], v[96:99], v[52:55]
v_mfma_f32_16x16x32_bf16 v[56:59], v[68:71], v[116:119], v[56:59]
v_mfma_f32_16x16x32_bf16 v[56:59], v[84:87], v[100:103], v[56:59]
v_mfma_f32_16x16x32_bf16 v[60:63], v[72:75], v[116:119], v[60:63]
v_mfma_f32_16x16x32_bf16 v[60:63], v[84:87], v[104:107], v[60:63]
v_mfma_f32_16x16x32_bf16 v[56:59], v[64:67], v[120:123], v[56:59]
v_mfma_f32_16x16x32_bf16 v[56:59], v[88:91], v[96:99], v[56:59]
v_mfma_f32_16x16x32_bf16 v[60:63], v[68:71], v[120:123], v[60:63]
v_mfma_f32_16x16x32_bf16 v[60:63], v[88:91], v[100:103], v[60:63]
v_mfma_f32_16x16x32_bf16 v[60:63], v[64:67], v[124:127], v[60:63]
v_mfma_f32_16x16x32_bf16 v[60:63], v[92:95], v[96:99], v[60:63]
s_waitcnt lgkmcnt(0)
v_mfma_f32_16x16x32_bf16 v[32:35], v[128:131], v[160:163], v[32:35]
ds_read_b64 v[64:65], v19 offset:3904
v_mfma_f32_16x16x32_bf16 v[36:39], v[128:131], v[164:167], v[36:39]
ds_read_b64 v[66:67], v19 offset:3912
v_mfma_f32_16x16x32_bf16 v[36:39], v[132:135], v[160:163], v[36:39]
ds_read_b128 v[96:99], v18 offset:64
v_mfma_f32_16x16x32_bf16 v[40:43], v[132:135], v[164:167], v[40:43]
ds_read_b64 v[68:69], v19 offset:3392
v_mfma_f32_16x16x32_bf16 v[40:43], v[128:131], v[168:171], v[40:43]
ds_read_b64 v[70:71], v19 offset:3400
v_mfma_f32_16x16x32_bf16 v[40:43], v[136:139], v[160:163], v[40:43]
ds_read_b128 v[100:103], v18 offset:576
v_mfma_f32_16x16x32_bf16 v[44:47], v[132:135], v[168:171], v[44:47]
ds_read_b64 v[72:73], v19 offset:2880
v_mfma_f32_16x16x32_bf16 v[44:47], v[136:139], v[164:167], v[44:47]
ds_read_b64 v[74:75], v19 offset:2888
v_mfma_f32_16x16x32_bf16 v[48:51], v[136:139], v[168:171], v[48:51]
ds_read_b128 v[104:107], v18 offset:1088
v_mfma_f32_16x16x32_bf16 v[44:47], v[128:131], v[172:175], v[44:47]
ds_read_b64 v[76:77], v19 offset:2368
v_mfma_f32_16x16x32_bf16 v[44:47], v[140:143], v[160:163], v[44:47]
ds_read_b64 v[78:79], v19 offset:2376
v_mfma_f32_16x16x32_bf16 v[48:51], v[132:135], v[172:175], v[48:51]
ds_read_b128 v[108:111], v18 offset:1600
v_mfma_f32_16x16x32_bf16 v[48:51], v[140:143], v[164:167], v[48:51]
ds_read_b64 v[80:81], v19 offset:1856
v_mfma_f32_16x16x32_bf16 v[52:55], v[136:139], v[172:175], v[52:55]
ds_read_b64 v[82:83], v19 offset:1864
v_mfma_f32_16x16x32_bf16 v[52:55], v[140:143], v[168:171], v[52:55]
ds_read_b128 v[112:115], v18 offset:2112
v_mfma_f32_16x16x32_bf16 v[56:59], v[140:143], v[172:175], v[56:59]
ds_read_b64 v[84:85], v19 offset:1344
v_mfma_f32_16x16x32_bf16 v[48:51], v[128:131], v[176:179], v[48:51]
ds_read_b64 v[86:87], v19 offset:1352
v_mfma_f32_16x16x32_bf16 v[48:51], v[144:147], v[160:163], v[48:51]
ds_read_b128 v[116:119], v18 offset:2624
v_mfma_f32_16x16x32_bf16 v[52:55], v[132:135], v[176:179], v[52:55]
ds_read_b64 v[88:89], v19 offset:832
v_mfma_f32_16x16x32_bf16 v[52:55], v[144:147], v[164:167], v[52:55]
ds_read_b64 v[90:91], v19 offset:840
v_mfma_f32_16x16x32_bf16 v[56:59], v[136:139], v[176:179], v[56:59]
ds_read_b128 v[120:123], v18 offset:3136
v_mfma_f32_16x16x32_bf16 v[56:59], v[144:147], v[168:171], v[56:59]
ds_read_b64 v[92:93], v19 offset:320
v_mfma_f32_16x16x32_bf16 v[60:63], v[140:143], v[176:179], v[60:63]
ds_read_b64 v[94:95], v19 offset:328
v_mfma_f32_16x16x32_bf16 v[60:63], v[144:147], v[172:175], v[60:63]
ds_read_b128 v[124:127], v18 offset:3648
v_mfma_f32_16x16x32_bf16 v[52:55], v[128:131], v[180:183], v[52:55]
v_mfma_f32_16x16x32_bf16 v[52:55], v[148:151], v[160:163], v[52:55]
v_mfma_f32_16x16x32_bf16 v[56:59], v[132:135], v[180:183], v[56:59]
v_mfma_f32_16x16x32_bf16 v[56:59], v[148:151], v[164:167], v[56:59]
v_mfma_f32_16x16x32_bf16 v[60:63], v[136:139], v[180:183], v[60:63]
v_mfma_f32_16x16x32_bf16 v[60:63], v[148:151], v[168:171], v[60:63]
v_mfma_f32_16x16x32_bf16 v[56:59], v[128:131], v[184:187], v[56:59]
v_mfma_f32_16x16x32_bf16 v[56:59], v[152:155], v[160:163], v[56:59]
v_mfma_f32_16x16x32_bf16 v[60:63], v[132:135], v[184:187], v[60:63]
v_mfma_f32_16x16x32_bf16 v[60:63], v[152:155], v[164:167], v[60:63]
v_mfma_f32_16x16x32_bf16 v[60:63], v[128:131], v[188:191], v[60:63]
v_mfma_f32_16x16x32_bf16 v[60:63], v[156:159], v[160:163], v[60:63]
s_waitcnt lgkmcnt(0)
v_mfma_f32_16x16x32_bf16 v[32:35], v[64:67], v[96:99], v[32:35]
ds_read_b64 v[128:129], v19 offset:3840
v_mfma_f32_16x16x32_bf16 v[36:39], v[64:67], v[100:103], v[36:39]
ds_read_b64 v[130:131], v19 offset:3848
v_mfma_f32_16x16x32_bf16 v[36:39], v[68:71], v[96:99], v[36:39]
ds_read_b128 v[160:163], v18 offset:0
v_mfma_f32_16x16x32_bf16 v[40:43], v[68:71], v[100:103], v[40:43]
ds_read_b64 v[132:133], v19 offset:3328
v_mfma_f32_16x16x32_bf16 v[40:43], v[64:67], v[104:107], v[40:43]
ds_read_b64 v[134:135], v19 offset:3336
v_mfma_f32_16x16x32_bf16 v[40:43], v[72:75], v[96:99], v[40:43]
ds_read_b128 v[164:167], v18 offset:512
v_mfma_f32_16x16x32_bf16 v[44:47], v[68:71], v[104:107], v[44:47]
ds_read_b64 v[136:137], v19 offset:2816
v_mfma_f32_16x16x32_bf16 v[44:47], v[72:75], v[100:103], v[44:47]
ds_read_b64 v[138:139], v19 offset:2824
v_mfma_f32_16x16x32_bf16 v[48:51], v[72:75], v[104:107], v[48:51]
ds_read_b128 v[168:171], v18 offset:1024
v_mfma_f32_16x16x32_bf16 v[44:47], v[64:67], v[108:111], v[44:47]
ds_read_b64 v[140:141], v19 offset:2304
v_mfma_f32_16x16x32_bf16 v[44:47], v[76:79], v[96:99], v[44:47]
ds_read_b64 v[142:143], v19 offset:2312
v_mfma_f32_16x16x32_bf16 v[48:51], v[68:71], v[108:111], v[48:51]
ds_read_b128 v[172:175], v18 offset:1536
v_mfma_f32_16x16x32_bf16 v[48:51], v[76:79], v[100:103], v[48:51]
ds_read_b64 v[144:145], v19 offset:1792
v_mfma_f32_16x16x32_bf16 v[52:55], v[72:75], v[108:111], v[52:55]
ds_read_b64 v[146:147], v19 offset:1800
v_mfma_f32_16x16x32_bf16 v[52:55], v[76:79], v[104:107], v[52:55]
ds_read_b128 v[176:179], v18 offset:2048
v_mfma_f32_16x16x32_bf16 v[56:59], v[76:79], v[108:111], v[56:59]
ds_read_b64 v[148:149], v19 offset:1280
v_mfma_f32_16x16x32_bf16 v[48:51], v[64:67], v[112:115], v[48:51]
ds_read_b64 v[150:151], v19 offset:1288
v_mfma_f32_16x16x32_bf16 v[48:51], v[80:83], v[96:99], v[48:51]
ds_read_b128 v[180:183], v18 offset:2560
v_mfma_f32_16x16x32_bf16 v[52:55], v[68:71], v[112:115], v[52:55]
ds_read_b64 v[152:153], v19 offset:768
v_mfma_f32_16x16x32_bf16 v[52:55], v[80:83], v[100:103], v[52:55]
ds_read_b64 v[154:155], v19 offset:776
v_mfma_f32_16x16x32_bf16 v[56:59], v[72:75], v[112:115], v[56:59]
ds_read_b128 v[184:187], v18 offset:3072
v_mfma_f32_16x16x32_bf16 v[56:59], v[80:83], v[104:107], v[56:59]
ds_read_b64 v[156:157], v19 offset:256
v_mfma_f32_16x16x32_bf16 v[60:63], v[76:79], v[112:115], v[60:63]
ds_read_b64 v[158:159], v19 offset:264
v_mfma_f32_16x16x32_bf16 v[60:63], v[80:83], v[108:111], v[60:63]
ds_read_b128 v[188:191], v18 offset:3584
v_mfma_f32_16x16x32_bf16 v[52:55], v[64:67], v[116:119], v[52:55]
v_mfma_f32_16x16x32_bf16 v[52:55], v[84:87], v[96:99], v[52:55]
v_mfma_f32_16x16x32_bf16 v[56:59], v[68:71], v[116:119], v[56:59]
v_mfma_f32_16x16x32_bf16 v[56:59], v[84:87], v[100:103], v[56:59]
v_mfma_f32_16x16x32_bf16 v[60:63], v[72:75], v[116:119], v[60:63]
v_mfma_f32_16x16x32_bf16 v[60:63], v[84:87], v[104:107], v[60:63]
v_mfma_f32_16x16x32_bf16 v[56:59], v[64:67], v[120:123], v[56:59]
v_mfma_f32_16x16x32_bf16 v[56:59], v[88:91], v[96:99], v[56:59]
v_mfma_f32_16x16x32_bf16 v[60:63], v[68:71], v[120:123], v[60:63]
v_mfma_f32_16x16x32_bf16 v[60:63], v[88:91], v[100:103], v[60:63]
v_mfma_f32_16x16x32_bf16 v[60:63], v[64:67], v[124:127], v[60:63]
v_mfma_f32_16x16x32_bf16 v[60:63], v[92:95], v[96:99], v[60:63]
s_waitcnt lgkmcnt(0)
ds_read_b64 v[200:201], v21 offset:1536
ds_read_b64 v[202:203], v21 offset:1024
ds_read_b64 v[204:205], v21 offset:512
ds_read_b64 v[206:207], v21 offset:0
v_mfma_f32_16x16x32_bf16 v[32:35], v[128:131], v[160:163], v[32:35]
v_mfma_f32_16x16x32_bf16 v[36:39], v[128:131], v[164:167], v[36:39]
v_mfma_f32_16x16x32_bf16 v[36:39], v[132:135], v[160:163], v[36:39]
v_mfma_f32_16x16x32_bf16 v[40:43], v[132:135], v[164:167], v[40:43]
v_mfma_f32_16x16x32_bf16 v[40:43], v[128:131], v[168:171], v[40:43]
v_mfma_f32_16x16x32_bf16 v[40:43], v[136:139], v[160:163], v[40:43]
v_mfma_f32_16x16x32_bf16 v[44:47], v[132:135], v[168:171], v[44:47]
v_mfma_f32_16x16x32_bf16 v[44:47], v[136:139], v[164:167], v[44:47]
v_mfma_f32_16x16x32_bf16 v[48:51], v[136:139], v[168:171], v[48:51]
s_waitcnt lgkmcnt(0)
v_mfma_f32_16x16x32_bf16 v[44:47], v[128:131], v[172:175], v[44:47]
v_and_b32 v216, s46, v201
v_lshlrev_b32 v217, 16, v201
v_mfma_f32_16x16x32_bf16 v[44:47], v[140:143], v[160:163], v[44:47]
v_and_b32 v218, s46, v200
v_lshlrev_b32 v219, 16, v200
v_mfma_f32_16x16x32_bf16 v[48:51], v[132:135], v[172:175], v[48:51]
v_and_b32 v220, s46, v203
v_lshlrev_b32 v221, 16, v203
v_mfma_f32_16x16x32_bf16 v[48:51], v[140:143], v[164:167], v[48:51]
v_and_b32 v222, s46, v202
v_lshlrev_b32 v223, 16, v202
v_mfma_f32_16x16x32_bf16 v[52:55], v[136:139], v[172:175], v[52:55]
v_and_b32 v224, s46, v205
v_lshlrev_b32 v225, 16, v205
v_mfma_f32_16x16x32_bf16 v[52:55], v[140:143], v[168:171], v[52:55]
v_and_b32 v226, s46, v204
v_lshlrev_b32 v227, 16, v204
v_mfma_f32_16x16x32_bf16 v[56:59], v[140:143], v[172:175], v[56:59]
v_and_b32 v228, s46, v207
v_lshlrev_b32 v229, 16, v207
v_mfma_f32_16x16x32_bf16 v[48:51], v[128:131], v[176:179], v[48:51]
v_and_b32 v230, s46, v206
v_lshlrev_b32 v231, 16, v206
v_mfma_f32_16x16x32_bf16 v[48:51], v[144:147], v[160:163], v[48:51]
v_mul_f32 v216, s33, v216
v_mul_f32 v217, s33, v217
v_mfma_f32_16x16x32_bf16 v[52:55], v[132:135], v[176:179], v[52:55]
v_mul_f32 v218, s33, v218
v_mul_f32 v219, s33, v219
v_mfma_f32_16x16x32_bf16 v[52:55], v[144:147], v[164:167], v[52:55]
v_mul_f32 v220, s33, v220
v_mul_f32 v221, s33, v221
v_mfma_f32_16x16x32_bf16 v[56:59], v[136:139], v[176:179], v[56:59]
v_mul_f32 v222, s33, v222
v_mul_f32 v223, s33, v223
v_mfma_f32_16x16x32_bf16 v[56:59], v[144:147], v[168:171], v[56:59]
v_mul_f32 v224, s33, v224
v_mul_f32 v225, s33, v225
v_mfma_f32_16x16x32_bf16 v[60:63], v[140:143], v[176:179], v[60:63]
v_mul_f32 v226, s33, v226
v_mul_f32 v227, s33, v227
v_mfma_f32_16x16x32_bf16 v[60:63], v[144:147], v[172:175], v[60:63]
v_mul_f32 v228, s33, v228
v_mul_f32 v229, s33, v229
v_mfma_f32_16x16x32_bf16 v[52:55], v[128:131], v[180:183], v[52:55]
v_mul_f32 v230, s33, v230
v_mul_f32 v231, s33, v231
v_mfma_f32_16x16x32_bf16 v[52:55], v[148:151], v[160:163], v[52:55]
v_cvt_pk_bf16_f32 v216, 0, v216
v_cvt_pk_bf16_f32 v217, 0, v217
v_mfma_f32_16x16x32_bf16 v[56:59], v[132:135], v[180:183], v[56:59]
v_cvt_pk_bf16_f32 v218, 0, v218
v_cvt_pk_bf16_f32 v219, 0, v219
v_mfma_f32_16x16x32_bf16 v[56:59], v[148:151], v[164:167], v[56:59]
v_cvt_pk_bf16_f32 v220, 0, v220
v_cvt_pk_bf16_f32 v221, 0, v221
v_mfma_f32_16x16x32_bf16 v[60:63], v[136:139], v[180:183], v[60:63]
v_cvt_pk_bf16_f32 v222, 0, v222
v_cvt_pk_bf16_f32 v223, 0, v223
v_mfma_f32_16x16x32_bf16 v[60:63], v[148:151], v[168:171], v[60:63]
v_cvt_pk_bf16_f32 v224, 0, v224
v_cvt_pk_bf16_f32 v225, 0, v225
v_mfma_f32_16x16x32_bf16 v[56:59], v[128:131], v[184:187], v[56:59]
v_cvt_pk_bf16_f32 v226, 0, v226
v_cvt_pk_bf16_f32 v227, 0, v227
v_mfma_f32_16x16x32_bf16 v[56:59], v[152:155], v[160:163], v[56:59]
v_cvt_pk_bf16_f32 v228, 0, v228
v_cvt_pk_bf16_f32 v229, 0, v229
v_mfma_f32_16x16x32_bf16 v[60:63], v[132:135], v[184:187], v[60:63]
v_cvt_pk_bf16_f32 v230, 0, v230
v_cvt_pk_bf16_f32 v231, 0, v231
v_mfma_f32_16x16x32_bf16 v[60:63], v[152:155], v[164:167], v[60:63]
v_mfma_f32_16x16x32_bf16 v[60:63], v[128:131], v[188:191], v[60:63]
v_mfma_f32_16x16x32_bf16 v[60:63], v[156:159], v[160:163], v[60:63]
s_nop 7
v_lshlrev_b32 v14, 4, v2
v_add_u32 v15, s54, v14
v_add_u32 v16, s55, v14
s_cmp_eq_u32 s28, 1
s_cbranch_scc1 L_h1_13
ds_write_b128 v15, v[48:51] offset:0
ds_write_b128 v15, v[52:55] offset:1024
ds_write_b128 v15, v[56:59] offset:2048
ds_write_b128 v15, v[60:63] offset:3072
s_branch L_hd_14
L_h1_13:
ds_write_b128 v15, v[32:35] offset:0
ds_write_b128 v15, v[36:39] offset:1024
ds_write_b128 v15, v[40:43] offset:2048
ds_write_b128 v15, v[44:47] offset:3072
L_hd_14:
s_waitcnt lgkmcnt(0)
s_barrier
ds_read_b128 v[80:83], v16 offset:0
ds_read_b128 v[84:87], v16 offset:1024
ds_read_b128 v[88:91], v16 offset:2048
ds_read_b128 v[92:95], v16 offset:3072
s_waitcnt lgkmcnt(0)
v_mov_b32 v22, s33
s_cmp_eq_u32 s28, 1
s_cbranch_scc1 L_h2_15
v_add_f32 v64, v32, v80
v_add_f32 v65, v33, v81
v_add_f32 v66, v34, v82
v_add_f32 v67, v35, v83
v_add_f32 v68, v36, v84
v_add_f32 v69, v37, v85
v_add_f32 v70, v38, v86
v_add_f32 v71, v39, v87
v_add_f32 v72, v40, v88
v_add_f32 v73, v41, v89
v_add_f32 v74, v42, v90
v_add_f32 v75, v43, v91
v_add_f32 v76, v44, v92
v_add_f32 v77, v45, v93
v_add_f32 v78, v46, v94
v_add_f32 v79, v47, v95
s_branch L_he_16
L_h2_15:
v_add_f32 v64, v48, v80
v_add_f32 v65, v49, v81
v_add_f32 v66, v50, v82
v_add_f32 v67, v51, v83
v_add_f32 v68, v52, v84
v_add_f32 v69, v53, v85
v_add_f32 v70, v54, v86
v_add_f32 v71, v55, v87
v_add_f32 v72, v56, v88
v_add_f32 v73, v57, v89
v_add_f32 v74, v58, v90
v_add_f32 v75, v59, v91
v_add_f32 v76, v60, v92
v_add_f32 v77, v61, v93
v_add_f32 v78, v62, v94
v_add_f32 v79, v63, v95
L_he_16:
v_cvt_pk_bf16_f32 v64, 0, v64
v_cvt_pk_bf16_f32 v65, 0, v65
v_cvt_pk_bf16_f32 v66, 0, v66
v_cvt_pk_bf16_f32 v67, 0, v67
v_add_f32 v26, v216, v64
v_add_f32 v27, v217, v65
v_add_f32 v28, v218, v66
v_add_f32 v29, v219, v67
v_cvt_pk_bf16_f32 v112, v26, v27
v_cvt_pk_bf16_f32 v113, v28, v29
v_cvt_pk_bf16_f32 v68, 0, v68
v_cvt_pk_bf16_f32 v69, 0, v69
v_cvt_pk_bf16_f32 v70, 0, v70
v_cvt_pk_bf16_f32 v71, 0, v71
v_add_f32 v26, v220, v68
v_add_f32 v27, v221, v69
v_add_f32 v28, v222, v70
v_add_f32 v29, v223, v71
v_cvt_pk_bf16_f32 v114, v26, v27
v_cvt_pk_bf16_f32 v115, v28, v29
v_cvt_pk_bf16_f32 v72, 0, v72
v_cvt_pk_bf16_f32 v73, 0, v73
v_cvt_pk_bf16_f32 v74, 0, v74
v_cvt_pk_bf16_f32 v75, 0, v75
v_add_f32 v26, v224, v72
v_add_f32 v27, v225, v73
v_add_f32 v28, v226, v74
v_add_f32 v29, v227, v75
v_cvt_pk_bf16_f32 v116, v26, v27
v_cvt_pk_bf16_f32 v117, v28, v29
v_cvt_pk_bf16_f32 v76, 0, v76
v_cvt_pk_bf16_f32 v77, 0, v77
v_cvt_pk_bf16_f32 v78, 0, v78
v_cvt_pk_bf16_f32 v79, 0, v79
v_add_f32 v26, v228, v76
v_add_f32 v27, v229, v77
v_add_f32 v28, v230, v78
v_add_f32 v29, v231, v79
v_cvt_pk_bf16_f32 v118, v26, v27
v_cvt_pk_bf16_f32 v119, v28, v29
s_lshl_b32 s56, s29, 12
s_lshl_b32 s57, s28, 11
s_add_u32 s56, s56, s57
s_add_u32 s56, s56, 10485760
s_add_u32 s36, s4, s56
s_addc_u32 s37, s5, 0
s_and_b32 s37, s37, 0xffff
s_mov_b32 s38, 2048
s_mov_b32 s39, 0x20000
buffer_store_dwordx2 v[112:113], v20, s[36:39], 0 offen offset:0 sc1
buffer_store_dwordx2 v[114:115], v20, s[36:39], 0 offen offset:512 sc1
buffer_store_dwordx2 v[116:117], v20, s[36:39], 0 offen offset:1024 sc1
buffer_store_dwordx2 v[118:119], v20, s[36:39], 0 offen offset:1536 sc1
s_branch L_ka_fin
L_ka_fin:
L_ka_end:
s_endpgm
.globl kb_kernel
.p2align 8
.type kb_kernel,@function
kb_kernel:
s_cmp_ge_u32 s2, 256
s_cbranch_scc1 L_kb_end_17
s_load_dwordx2 s[4:5], s[0:1], 120
s_load_dwordx2 s[6:7], s[0:1], 104
v_lshrrev_b32 v1, 6, v0
v_and_b32 v2, 63, v0
s_and_b32 s8, s2, 7
v_readfirstlane_b32 s9, v1
s_lshr_b32 s10, s2, 3
s_and_b32 s11, s10, 3
s_lshl_b32 s8, s8, 2
s_add_u32 s8, s8, s11
s_lshr_b32 s10, s10, 2
v_lshlrev_b32 v3, 4, v2
s_mul_i32 s12, s9, 14
s_mul_i32 s13, s8, 56
s_add_u32 s13, s13, s12
s_lshl_b32 s13, s13, 12
s_mul_i32 s14, s10, 56
s_add_u32 s14, s14, s12
s_lshl_b32 s14, s14, 12
s_add_u32 s14, s14, 8388608
v_lshrrev_b32 v4, 3, v2
v_lshlrev_b32 v4, 12, v4
v_and_b32 v5, 7, v2
v_lshlrev_b32 v5, 4, v5
v_add_u32 v4, v4, v5
s_lshl_b32 s15, s10, 6
s_lshl_b32 s16, s9, 4
s_add_u32 s15, s15, s16
s_lshl_b32 s15, s15, 12
s_lshl_b32 s16, s8, 7
s_add_u32 s15, s15, s16
s_add_u32 s15, s15, 10485760
v_and_b32 v5, 15, v2
v_lshlrev_b32 v6, 2, v5
s_lshl_b32 s17, s8, 8
s_lshl_b32 s18, s9, 6
s_add_u32 s17, s17, s18
s_add_u32 s17, s17, 12582912
s_waitcnt lgkmcnt(0)
s_add_u32 s20, s4, s13
s_addc_u32 s21, s5, 0
s_and_b32 s21, s21, 0xffff
s_mov_b32 s22, 57344
s_mov_b32 s23, 0x20000
s_add_u32 s24, s4, s14
s_addc_u32 s25, s5, 0
s_and_b32 s25, s25, 0xffff
s_mov_b32 s26, 57344
s_mov_b32 s27, 0x20000
s_add_u32 s28, s4, s15
s_addc_u32 s29, s5, 0
s_and_b32 s29, s29, 0xffff
s_mov_b32 s30, 65536
s_mov_b32 s31, 0x20000
s_add_u32 s32, s4, s17
s_addc_u32 s33, s5, 0
s_and_b32 s33, s33, 0xffff
s_mov_b32 s34, 64
s_mov_b32 s35, 0x20000
s_mov_b32 s48, 0
buffer_load_dwordx4 v[8:11], v3, s[24:27], s48 offen offset:0
buffer_load_dwordx4 v[24:27], v3, s[20:23], s48 offen offset:0
buffer_load_dwordx4 v[12:15], v3, s[24:27], s48 offen offset:1024
buffer_load_dwordx4 v[28:31], v3, s[20:23], s48 offen offset:1024
buffer_load_dwordx4 v[16:19], v3, s[24:27], s48 offen offset:2048
buffer_load_dwordx4 v[32:35], v3, s[20:23], s48 offen offset:2048
buffer_load_dwordx4 v[20:23], v3, s[24:27], s48 offen offset:3072
buffer_load_dwordx4 v[36:39], v3, s[20:23], s48 offen offset:3072
s_mov_b32 s49, 4096
buffer_load_dwordx4 v[40:43], v3, s[24:27], s49 offen offset:0
buffer_load_dwordx4 v[56:59], v3, s[20:23], s49 offen offset:0
buffer_load_dwordx4 v[44:47], v3, s[24:27], s49 offen offset:1024
buffer_load_dwordx4 v[60:63], v3, s[20:23], s49 offen offset:1024
buffer_load_dwordx4 v[48:51], v3, s[24:27], s49 offen offset:2048
buffer_load_dwordx4 v[64:67], v3, s[20:23], s49 offen offset:2048
buffer_load_dwordx4 v[52:55], v3, s[24:27], s49 offen offset:3072
buffer_load_dwordx4 v[68:71], v3, s[20:23], s49 offen offset:3072
s_lshl_b32 s19, s9, 11
s_add_u32 s19, s19, 65536
s_mov_b32 m0, s19
s_mov_b32 s36, 32768
buffer_load_dwordx4 v4, s[28:31], 0 offen lds
s_add_u32 s19, s19, 1024
s_mov_b32 m0, s19
s_nop 0
buffer_load_dwordx4 v4, s[28:31], s36 offen lds
buffer_load_dword v7, v6, s[32:35], 0 offen
v_lshrrev_b32 v129, 4, v2
v_lshlrev_b32 v128, 10, v129
v_lshrrev_b32 v129, 2, v2
v_and_b32 v129, 3, v129
v_lshlrev_b32 v129, 7, v129
v_add_u32 v128, v128, v129
v_and_b32 v129, 3, v2
v_lshlrev_b32 v129, 3, v129
v_add_u32 v128, v128, v129
s_lshl_b32 s38, s9, 5
s_add_u32 s38, s38, 65536
v_add_u32 v128, s38, v128
s_mov_b32 s40, 0xffff0000
v_accvgpr_write_b32 a0, 0
v_accvgpr_write_b32 a1, 0
v_accvgpr_write_b32 a2, 0
v_accvgpr_write_b32 a3, 0
v_accvgpr_write_b32 a4, 0
v_accvgpr_write_b32 a5, 0
v_accvgpr_write_b32 a6, 0
v_accvgpr_write_b32 a7, 0
v_accvgpr_write_b32 a8, 0
v_accvgpr_write_b32 a9, 0
v_accvgpr_write_b32 a10, 0
v_accvgpr_write_b32 a11, 0
v_accvgpr_write_b32 a12, 0
v_accvgpr_write_b32 a13, 0
v_accvgpr_write_b32 a14, 0
v_accvgpr_write_b32 a15, 0
v_accvgpr_write_b32 a16, 0
v_accvgpr_write_b32 a17, 0
v_accvgpr_write_b32 a18, 0
v_accvgpr_write_b32 a19, 0
v_accvgpr_write_b32 a20, 0
v_accvgpr_write_b32 a21, 0
v_accvgpr_write_b32 a22, 0
v_accvgpr_write_b32 a23, 0
v_accvgpr_write_b32 a24, 0
v_accvgpr_write_b32 a25, 0
v_accvgpr_write_b32 a26, 0
v_accvgpr_write_b32 a27, 0
v_accvgpr_write_b32 a28, 0
v_accvgpr_write_b32 a29, 0
v_accvgpr_write_b32 a30, 0
v_accvgpr_write_b32 a31, 0
v_accvgpr_write_b32 a32, 0
v_accvgpr_write_b32 a33, 0
v_accvgpr_write_b32 a34, 0
v_accvgpr_write_b32 a35, 0
v_accvgpr_write_b32 a36, 0
v_accvgpr_write_b32 a37, 0
v_accvgpr_write_b32 a38, 0
v_accvgpr_write_b32 a39, 0
v_accvgpr_write_b32 a40, 0
v_accvgpr_write_b32 a41, 0
v_accvgpr_write_b32 a42, 0
v_accvgpr_write_b32 a43, 0
v_accvgpr_write_b32 a44, 0
v_accvgpr_write_b32 a45, 0
v_accvgpr_write_b32 a46, 0
v_accvgpr_write_b32 a47, 0
v_accvgpr_write_b32 a48, 0
v_accvgpr_write_b32 a49, 0
v_accvgpr_write_b32 a50, 0
v_accvgpr_write_b32 a51, 0
v_accvgpr_write_b32 a52, 0
v_accvgpr_write_b32 a53, 0
v_accvgpr_write_b32 a54, 0
v_accvgpr_write_b32 a55, 0
v_accvgpr_write_b32 a56, 0
v_accvgpr_write_b32 a57, 0
v_accvgpr_write_b32 a58, 0
v_accvgpr_write_b32 a59, 0
v_accvgpr_write_b32 a60, 0
v_accvgpr_write_b32 a61, 0
v_accvgpr_write_b32 a62, 0
v_accvgpr_write_b32 a63, 0
s_waitcnt vmcnt(11)
s_mov_b32 s48, 8192
v_mfma_f32_16x16x32_bf16 a[0:3], v[8:11], v[24:27], a[0:3]
buffer_load_dwordx4 v[72:75], v3, s[24:27], s48 offen offset:0
v_mfma_f32_16x16x32_bf16 a[4:7], v[8:11], v[28:31], a[4:7]
v_mfma_f32_16x16x32_bf16 a[8:11], v[8:11], v[32:35], a[8:11]
buffer_load_dwordx4 v[88:91], v3, s[20:23], s48 offen offset:0
v_mfma_f32_16x16x32_bf16 a[12:15], v[8:11], v[36:39], a[12:15]
v_mfma_f32_16x16x32_bf16 a[16:19], v[12:15], v[24:27], a[16:19]
buffer_load_dwordx4 v[76:79], v3, s[24:27], s48 offen offset:1024
v_mfma_f32_16x16x32_bf16 a[20:23], v[12:15], v[28:31], a[20:23]
v_mfma_f32_16x16x32_bf16 a[24:27], v[12:15], v[32:35], a[24:27]
buffer_load_dwordx4 v[92:95], v3, s[20:23], s48 offen offset:1024
v_mfma_f32_16x16x32_bf16 a[28:31], v[12:15], v[36:39], a[28:31]
v_mfma_f32_16x16x32_bf16 a[32:35], v[16:19], v[24:27], a[32:35]
buffer_load_dwordx4 v[80:83], v3, s[24:27], s48 offen offset:2048
v_mfma_f32_16x16x32_bf16 a[36:39], v[16:19], v[28:31], a[36:39]
v_mfma_f32_16x16x32_bf16 a[40:43], v[16:19], v[32:35], a[40:43]
buffer_load_dwordx4 v[96:99], v3, s[20:23], s48 offen offset:2048
v_mfma_f32_16x16x32_bf16 a[44:47], v[16:19], v[36:39], a[44:47]
v_mfma_f32_16x16x32_bf16 a[48:51], v[20:23], v[24:27], a[48:51]
buffer_load_dwordx4 v[84:87], v3, s[24:27], s48 offen offset:3072
v_mfma_f32_16x16x32_bf16 a[52:55], v[20:23], v[28:31], a[52:55]
v_mfma_f32_16x16x32_bf16 a[56:59], v[20:23], v[32:35], a[56:59]
buffer_load_dwordx4 v[100:103], v3, s[20:23], s48 offen offset:3072
v_mfma_f32_16x16x32_bf16 a[60:63], v[20:23], v[36:39], a[60:63]
s_waitcnt vmcnt(11)
s_mov_b32 s49, 12288
v_mfma_f32_16x16x32_bf16 a[0:3], v[40:43], v[56:59], a[0:3]
buffer_load_dwordx4 v[8:11], v3, s[24:27], s49 offen offset:0
v_mfma_f32_16x16x32_bf16 a[4:7], v[40:43], v[60:63], a[4:7]
v_mfma_f32_16x16x32_bf16 a[8:11], v[40:43], v[64:67], a[8:11]
buffer_load_dwordx4 v[24:27], v3, s[20:23], s49 offen offset:0
v_mfma_f32_16x16x32_bf16 a[12:15], v[40:43], v[68:71], a[12:15]
v_mfma_f32_16x16x32_bf16 a[16:19], v[44:47], v[56:59], a[16:19]
buffer_load_dwordx4 v[12:15], v3, s[24:27], s49 offen offset:1024
v_mfma_f32_16x16x32_bf16 a[20:23], v[44:47], v[60:63], a[20:23]
v_mfma_f32_16x16x32_bf16 a[24:27], v[44:47], v[64:67], a[24:27]
buffer_load_dwordx4 v[28:31], v3, s[20:23], s49 offen offset:1024
v_mfma_f32_16x16x32_bf16 a[28:31], v[44:47], v[68:71], a[28:31]
v_mfma_f32_16x16x32_bf16 a[32:35], v[48:51], v[56:59], a[32:35]
buffer_load_dwordx4 v[16:19], v3, s[24:27], s49 offen offset:2048
v_mfma_f32_16x16x32_bf16 a[36:39], v[48:51], v[60:63], a[36:39]
v_mfma_f32_16x16x32_bf16 a[40:43], v[48:51], v[64:67], a[40:43]
buffer_load_dwordx4 v[32:35], v3, s[20:23], s49 offen offset:2048
v_mfma_f32_16x16x32_bf16 a[44:47], v[48:51], v[68:71], a[44:47]
v_mfma_f32_16x16x32_bf16 a[48:51], v[52:55], v[56:59], a[48:51]
buffer_load_dwordx4 v[20:23], v3, s[24:27], s49 offen offset:3072
v_mfma_f32_16x16x32_bf16 a[52:55], v[52:55], v[60:63], a[52:55]
v_mfma_f32_16x16x32_bf16 a[56:59], v[52:55], v[64:67], a[56:59]
buffer_load_dwordx4 v[36:39], v3, s[20:23], s49 offen offset:3072
v_mfma_f32_16x16x32_bf16 a[60:63], v[52:55], v[68:71], a[60:63]
s_waitcnt vmcnt(8)
s_mov_b32 s48, 16384
v_mfma_f32_16x16x32_bf16 a[0:3], v[72:75], v[88:91], a[0:3]
buffer_load_dwordx4 v[40:43], v3, s[24:27], s48 offen offset:0
v_mfma_f32_16x16x32_bf16 a[4:7], v[72:75], v[92:95], a[4:7]
v_mfma_f32_16x16x32_bf16 a[8:11], v[72:75], v[96:99], a[8:11]
buffer_load_dwordx4 v[56:59], v3, s[20:23], s48 offen offset:0
v_mfma_f32_16x16x32_bf16 a[12:15], v[72:75], v[100:103], a[12:15]
v_mfma_f32_16x16x32_bf16 a[16:19], v[76:79], v[88:91], a[16:19]
buffer_load_dwordx4 v[44:47], v3, s[24:27], s48 offen offset:1024
v_mfma_f32_16x16x32_bf16 a[20:23], v[76:79], v[92:95], a[20:23]
v_mfma_f32_16x16x32_bf16 a[24:27], v[76:79], v[96:99], a[24:27]
buffer_load_dwordx4 v[60:63], v3, s[20:23], s48 offen offset:1024
v_mfma_f32_16x16x32_bf16 a[28:31], v[76:79], v[100:103], a[28:31]
v_mfma_f32_16x16x32_bf16 a[32:35], v[80:83], v[88:91], a[32:35]
buffer_load_dwordx4 v[48:51], v3, s[24:27], s48 offen offset:2048
v_mfma_f32_16x16x32_bf16 a[36:39], v[80:83], v[92:95], a[36:39]
v_mfma_f32_16x16x32_bf16 a[40:43], v[80:83], v[96:99], a[40:43]
buffer_load_dwordx4 v[64:67], v3, s[20:23], s48 offen offset:2048
v_mfma_f32_16x16x32_bf16 a[44:47], v[80:83], v[100:103], a[44:47]
v_mfma_f32_16x16x32_bf16 a[48:51], v[84:87], v[88:91], a[48:51]
buffer_load_dwordx4 v[52:55], v3, s[24:27], s48 offen offset:3072
v_mfma_f32_16x16x32_bf16 a[52:55], v[84:87], v[92:95], a[52:55]
v_mfma_f32_16x16x32_bf16 a[56:59], v[84:87], v[96:99], a[56:59]
buffer_load_dwordx4 v[68:71], v3, s[20:23], s48 offen offset:3072
v_mfma_f32_16x16x32_bf16 a[60:63], v[84:87], v[100:103], a[60:63]
s_waitcnt vmcnt(8)
s_mov_b32 s49, 20480
s_barrier
ds_read_b64_tr_b16 v[120:121], v128 offset:0
ds_read_b64_tr_b16 v[122:123], v128 offset:512
ds_read_b64_tr_b16 v[124:125], v128 offset:4096
ds_read_b64_tr_b16 v[126:127], v128 offset:4608
v_mfma_f32_16x16x32_bf16 a[0:3], v[8:11], v[24:27], a[0:3]
buffer_load_dwordx4 v[72:75], v3, s[24:27], s49 offen offset:0
v_mfma_f32_16x16x32_bf16 a[4:7], v[8:11], v[28:31], a[4:7]
v_mfma_f32_16x16x32_bf16 a[8:11], v[8:11], v[32:35], a[8:11]
buffer_load_dwordx4 v[88:91], v3, s[20:23], s49 offen offset:0
v_mfma_f32_16x16x32_bf16 a[12:15], v[8:11], v[36:39], a[12:15]
v_mfma_f32_16x16x32_bf16 a[16:19], v[12:15], v[24:27], a[16:19]
buffer_load_dwordx4 v[76:79], v3, s[24:27], s49 offen offset:1024
v_mfma_f32_16x16x32_bf16 a[20:23], v[12:15], v[28:31], a[20:23]
v_mfma_f32_16x16x32_bf16 a[24:27], v[12:15], v[32:35], a[24:27]
buffer_load_dwordx4 v[92:95], v3, s[20:23], s49 offen offset:1024
v_mfma_f32_16x16x32_bf16 a[28:31], v[12:15], v[36:39], a[28:31]
v_mfma_f32_16x16x32_bf16 a[32:35], v[16:19], v[24:27], a[32:35]
buffer_load_dwordx4 v[80:83], v3, s[24:27], s49 offen offset:2048
v_mfma_f32_16x16x32_bf16 a[36:39], v[16:19], v[28:31], a[36:39]
v_mfma_f32_16x16x32_bf16 a[40:43], v[16:19], v[32:35], a[40:43]
buffer_load_dwordx4 v[96:99], v3, s[20:23], s49 offen offset:2048
v_mfma_f32_16x16x32_bf16 a[44:47], v[16:19], v[36:39], a[44:47]
v_mfma_f32_16x16x32_bf16 a[48:51], v[20:23], v[24:27], a[48:51]
buffer_load_dwordx4 v[84:87], v3, s[24:27], s49 offen offset:3072
v_mfma_f32_16x16x32_bf16 a[52:55], v[20:23], v[28:31], a[52:55]
v_mfma_f32_16x16x32_bf16 a[56:59], v[20:23], v[32:35], a[56:59]
buffer_load_dwordx4 v[100:103], v3, s[20:23], s49 offen offset:3072
v_mfma_f32_16x16x32_bf16 a[60:63], v[20:23], v[36:39], a[60:63]
s_waitcnt vmcnt(8)
s_mov_b32 s48, 24576
v_mfma_f32_16x16x32_bf16 a[0:3], v[40:43], v[56:59], a[0:3]
buffer_load_dwordx4 v[8:11], v3, s[24:27], s48 offen offset:0
v_mfma_f32_16x16x32_bf16 a[4:7], v[40:43], v[60:63], a[4:7]
v_mfma_f32_16x16x32_bf16 a[8:11], v[40:43], v[64:67], a[8:11]
buffer_load_dwordx4 v[24:27], v3, s[20:23], s48 offen offset:0
v_mfma_f32_16x16x32_bf16 a[12:15], v[40:43], v[68:71], a[12:15]
v_mfma_f32_16x16x32_bf16 a[16:19], v[44:47], v[56:59], a[16:19]
buffer_load_dwordx4 v[12:15], v3, s[24:27], s48 offen offset:1024
v_mfma_f32_16x16x32_bf16 a[20:23], v[44:47], v[60:63], a[20:23]
v_mfma_f32_16x16x32_bf16 a[24:27], v[44:47], v[64:67], a[24:27]
buffer_load_dwordx4 v[28:31], v3, s[20:23], s48 offen offset:1024
v_mfma_f32_16x16x32_bf16 a[28:31], v[44:47], v[68:71], a[28:31]
v_mfma_f32_16x16x32_bf16 a[32:35], v[48:51], v[56:59], a[32:35]
buffer_load_dwordx4 v[16:19], v3, s[24:27], s48 offen offset:2048
v_mfma_f32_16x16x32_bf16 a[36:39], v[48:51], v[60:63], a[36:39]
v_mfma_f32_16x16x32_bf16 a[40:43], v[48:51], v[64:67], a[40:43]
buffer_load_dwordx4 v[32:35], v3, s[20:23], s48 offen offset:2048
v_mfma_f32_16x16x32_bf16 a[44:47], v[48:51], v[68:71], a[44:47]
v_mfma_f32_16x16x32_bf16 a[48:51], v[52:55], v[56:59], a[48:51]
buffer_load_dwordx4 v[20:23], v3, s[24:27], s48 offen offset:3072
v_mfma_f32_16x16x32_bf16 a[52:55], v[52:55], v[60:63], a[52:55]
v_mfma_f32_16x16x32_bf16 a[56:59], v[52:55], v[64:67], a[56:59]
buffer_load_dwordx4 v[36:39], v3, s[20:23], s48 offen offset:3072
v_mfma_f32_16x16x32_bf16 a[60:63], v[52:55], v[68:71], a[60:63]
s_waitcnt vmcnt(8)
s_mov_b32 s49, 28672
s_waitcnt lgkmcnt(0)
v_mfma_f32_16x16x32_bf16 a[0:3], v[72:75], v[88:91], a[0:3]
buffer_load_dwordx4 v[40:43], v3, s[24:27], s49 offen offset:0
v_lshlrev_b32 v104, 16, v120
v_and_b32 v105, s40, v120
v_lshlrev_b32 v106, 16, v121
v_mfma_f32_16x16x32_bf16 a[4:7], v[72:75], v[92:95], a[4:7]
v_and_b32 v107, s40, v121
v_lshlrev_b32 v108, 16, v122
v_and_b32 v109, s40, v122
v_mfma_f32_16x16x32_bf16 a[8:11], v[72:75], v[96:99], a[8:11]
buffer_load_dwordx4 v[56:59], v3, s[20:23], s49 offen offset:0
v_lshlrev_b32 v110, 16, v123
v_and_b32 v111, s40, v123
v_lshlrev_b32 v112, 16, v124
v_mfma_f32_16x16x32_bf16 a[12:15], v[72:75], v[100:103], a[12:15]
v_and_b32 v113, s40, v124
v_lshlrev_b32 v114, 16, v125
v_and_b32 v115, s40, v125
v_mfma_f32_16x16x32_bf16 a[16:19], v[76:79], v[88:91], a[16:19]
buffer_load_dwordx4 v[44:47], v3, s[24:27], s49 offen offset:1024
v_lshlrev_b32 v116, 16, v126
v_and_b32 v117, s40, v126
v_lshlrev_b32 v118, 16, v127
v_mfma_f32_16x16x32_bf16 a[20:23], v[76:79], v[92:95], a[20:23]
v_and_b32 v119, s40, v127
v_mul_f32 v104, v7, v104
v_mul_f32 v105, v7, v105
v_mfma_f32_16x16x32_bf16 a[24:27], v[76:79], v[96:99], a[24:27]
buffer_load_dwordx4 v[60:63], v3, s[20:23], s49 offen offset:1024
v_mul_f32 v106, v7, v106
v_mul_f32 v107, v7, v107
v_mul_f32 v108, v7, v108
v_mfma_f32_16x16x32_bf16 a[28:31], v[76:79], v[100:103], a[28:31]
v_mul_f32 v109, v7, v109
v_mul_f32 v110, v7, v110
v_mul_f32 v111, v7, v111
v_mfma_f32_16x16x32_bf16 a[32:35], v[80:83], v[88:91], a[32:35]
buffer_load_dwordx4 v[48:51], v3, s[24:27], s49 offen offset:2048
v_mul_f32 v112, v7, v112
v_mul_f32 v113, v7, v113
v_mul_f32 v114, v7, v114
v_mfma_f32_16x16x32_bf16 a[36:39], v[80:83], v[92:95], a[36:39]
v_mul_f32 v115, v7, v115
v_mul_f32 v116, v7, v116
v_mul_f32 v117, v7, v117
v_mfma_f32_16x16x32_bf16 a[40:43], v[80:83], v[96:99], a[40:43]
buffer_load_dwordx4 v[64:67], v3, s[20:23], s49 offen offset:2048
v_mul_f32 v118, v7, v118
v_mul_f32 v119, v7, v119
v_cvt_pk_bf16_f32 v104, 0, v104
v_mfma_f32_16x16x32_bf16 a[44:47], v[80:83], v[100:103], a[44:47]
v_cvt_pk_bf16_f32 v105, 0, v105
v_cvt_pk_bf16_f32 v106, 0, v106
v_cvt_pk_bf16_f32 v107, 0, v107
v_mfma_f32_16x16x32_bf16 a[48:51], v[84:87], v[88:91], a[48:51]
buffer_load_dwordx4 v[52:55], v3, s[24:27], s49 offen offset:3072
v_cvt_pk_bf16_f32 v108, 0, v108
v_cvt_pk_bf16_f32 v109, 0, v109
v_cvt_pk_bf16_f32 v110, 0, v110
v_mfma_f32_16x16x32_bf16 a[52:55], v[84:87], v[92:95], a[52:55]
v_cvt_pk_bf16_f32 v111, 0, v111
v_cvt_pk_bf16_f32 v112, 0, v112
v_cvt_pk_bf16_f32 v113, 0, v113
v_mfma_f32_16x16x32_bf16 a[56:59], v[84:87], v[96:99], a[56:59]
buffer_load_dwordx4 v[68:71], v3, s[20:23], s49 offen offset:3072
v_cvt_pk_bf16_f32 v114, 0, v114
v_cvt_pk_bf16_f32 v115, 0, v115
v_cvt_pk_bf16_f32 v116, 0, v116
v_mfma_f32_16x16x32_bf16 a[60:63], v[84:87], v[100:103], a[60:63]
v_cvt_pk_bf16_f32 v117, 0, v117
v_cvt_pk_bf16_f32 v118, 0, v118
v_cvt_pk_bf16_f32 v119, 0, v119
s_waitcnt vmcnt(8)
s_mov_b32 s48, 32768
v_mfma_f32_16x16x32_bf16 a[0:3], v[8:11], v[24:27], a[0:3]
buffer_load_dwordx4 v[72:75], v3, s[24:27], s48 offen offset:0
v_mfma_f32_16x16x32_bf16 a[4:7], v[8:11], v[28:31], a[4:7]
v_mfma_f32_16x16x32_bf16 a[8:11], v[8:11], v[32:35], a[8:11]
buffer_load_dwordx4 v[88:91], v3, s[20:23], s48 offen offset:0
v_mfma_f32_16x16x32_bf16 a[12:15], v[8:11], v[36:39], a[12:15]
v_mfma_f32_16x16x32_bf16 a[16:19], v[12:15], v[24:27], a[16:19]
buffer_load_dwordx4 v[76:79], v3, s[24:27], s48 offen offset:1024
v_mfma_f32_16x16x32_bf16 a[20:23], v[12:15], v[28:31], a[20:23]
v_mfma_f32_16x16x32_bf16 a[24:27], v[12:15], v[32:35], a[24:27]
buffer_load_dwordx4 v[92:95], v3, s[20:23], s48 offen offset:1024
v_mfma_f32_16x16x32_bf16 a[28:31], v[12:15], v[36:39], a[28:31]
v_mfma_f32_16x16x32_bf16 a[32:35], v[16:19], v[24:27], a[32:35]
buffer_load_dwordx4 v[80:83], v3, s[24:27], s48 offen offset:2048
v_mfma_f32_16x16x32_bf16 a[36:39], v[16:19], v[28:31], a[36:39]
v_mfma_f32_16x16x32_bf16 a[40:43], v[16:19], v[32:35], a[40:43]
buffer_load_dwordx4 v[96:99], v3, s[20:23], s48 offen offset:2048
v_mfma_f32_16x16x32_bf16 a[44:47], v[16:19], v[36:39], a[44:47]
v_mfma_f32_16x16x32_bf16 a[48:51], v[20:23], v[24:27], a[48:51]
buffer_load_dwordx4 v[84:87], v3, s[24:27], s48 offen offset:3072
v_mfma_f32_16x16x32_bf16 a[52:55], v[20:23], v[28:31], a[52:55]
v_mfma_f32_16x16x32_bf16 a[56:59], v[20:23], v[32:35], a[56:59]
buffer_load_dwordx4 v[100:103], v3, s[20:23], s48 offen offset:3072
v_mfma_f32_16x16x32_bf16 a[60:63], v[20:23], v[36:39], a[60:63]
s_waitcnt vmcnt(8)
s_mov_b32 s49, 36864
v_mfma_f32_16x16x32_bf16 a[0:3], v[40:43], v[56:59], a[0:3]
buffer_load_dwordx4 v[8:11], v3, s[24:27], s49 offen offset:0
v_mfma_f32_16x16x32_bf16 a[4:7], v[40:43], v[60:63], a[4:7]
v_mfma_f32_16x16x32_bf16 a[8:11], v[40:43], v[64:67], a[8:11]
buffer_load_dwordx4 v[24:27], v3, s[20:23], s49 offen offset:0
v_mfma_f32_16x16x32_bf16 a[12:15], v[40:43], v[68:71], a[12:15]
v_mfma_f32_16x16x32_bf16 a[16:19], v[44:47], v[56:59], a[16:19]
buffer_load_dwordx4 v[12:15], v3, s[24:27], s49 offen offset:1024
v_mfma_f32_16x16x32_bf16 a[20:23], v[44:47], v[60:63], a[20:23]
v_mfma_f32_16x16x32_bf16 a[24:27], v[44:47], v[64:67], a[24:27]
buffer_load_dwordx4 v[28:31], v3, s[20:23], s49 offen offset:1024
v_mfma_f32_16x16x32_bf16 a[28:31], v[44:47], v[68:71], a[28:31]
v_mfma_f32_16x16x32_bf16 a[32:35], v[48:51], v[56:59], a[32:35]
buffer_load_dwordx4 v[16:19], v3, s[24:27], s49 offen offset:2048
v_mfma_f32_16x16x32_bf16 a[36:39], v[48:51], v[60:63], a[36:39]
v_mfma_f32_16x16x32_bf16 a[40:43], v[48:51], v[64:67], a[40:43]
buffer_load_dwordx4 v[32:35], v3, s[20:23], s49 offen offset:2048
v_mfma_f32_16x16x32_bf16 a[44:47], v[48:51], v[68:71], a[44:47]
v_mfma_f32_16x16x32_bf16 a[48:51], v[52:55], v[56:59], a[48:51]
buffer_load_dwordx4 v[20:23], v3, s[24:27], s49 offen offset:3072
v_mfma_f32_16x16x32_bf16 a[52:55], v[52:55], v[60:63], a[52:55]
v_mfma_f32_16x16x32_bf16 a[56:59], v[52:55], v[64:67], a[56:59]
buffer_load_dwordx4 v[36:39], v3, s[20:23], s49 offen offset:3072
v_mfma_f32_16x16x32_bf16 a[60:63], v[52:55], v[68:71], a[60:63]
s_waitcnt vmcnt(8)
s_mov_b32 s48, 40960
v_mfma_f32_16x16x32_bf16 a[0:3], v[72:75], v[88:91], a[0:3]
buffer_load_dwordx4 v[40:43], v3, s[24:27], s48 offen offset:0
v_mfma_f32_16x16x32_bf16 a[4:7], v[72:75], v[92:95], a[4:7]
v_mfma_f32_16x16x32_bf16 a[8:11], v[72:75], v[96:99], a[8:11]
buffer_load_dwordx4 v[56:59], v3, s[20:23], s48 offen offset:0
v_mfma_f32_16x16x32_bf16 a[12:15], v[72:75], v[100:103], a[12:15]
v_mfma_f32_16x16x32_bf16 a[16:19], v[76:79], v[88:91], a[16:19]
buffer_load_dwordx4 v[44:47], v3, s[24:27], s48 offen offset:1024
v_mfma_f32_16x16x32_bf16 a[20:23], v[76:79], v[92:95], a[20:23]
v_mfma_f32_16x16x32_bf16 a[24:27], v[76:79], v[96:99], a[24:27]
buffer_load_dwordx4 v[60:63], v3, s[20:23], s48 offen offset:1024
v_mfma_f32_16x16x32_bf16 a[28:31], v[76:79], v[100:103], a[28:31]
v_mfma_f32_16x16x32_bf16 a[32:35], v[80:83], v[88:91], a[32:35]
buffer_load_dwordx4 v[48:51], v3, s[24:27], s48 offen offset:2048
v_mfma_f32_16x16x32_bf16 a[36:39], v[80:83], v[92:95], a[36:39]
v_mfma_f32_16x16x32_bf16 a[40:43], v[80:83], v[96:99], a[40:43]
buffer_load_dwordx4 v[64:67], v3, s[20:23], s48 offen offset:2048
v_mfma_f32_16x16x32_bf16 a[44:47], v[80:83], v[100:103], a[44:47]
v_mfma_f32_16x16x32_bf16 a[48:51], v[84:87], v[88:91], a[48:51]
buffer_load_dwordx4 v[52:55], v3, s[24:27], s48 offen offset:3072
v_mfma_f32_16x16x32_bf16 a[52:55], v[84:87], v[92:95], a[52:55]
v_mfma_f32_16x16x32_bf16 a[56:59], v[84:87], v[96:99], a[56:59]
buffer_load_dwordx4 v[68:71], v3, s[20:23], s48 offen offset:3072
v_mfma_f32_16x16x32_bf16 a[60:63], v[84:87], v[100:103], a[60:63]
s_waitcnt vmcnt(8)
s_mov_b32 s49, 45056
v_mfma_f32_16x16x32_bf16 a[0:3], v[8:11], v[24:27], a[0:3]
buffer_load_dwordx4 v[72:75], v3, s[24:27], s49 offen offset:0
v_mfma_f32_16x16x32_bf16 a[4:7], v[8:11], v[28:31], a[4:7]
v_mfma_f32_16x16x32_bf16 a[8:11], v[8:11], v[32:35], a[8:11]
buffer_load_dwordx4 v[88:91], v3, s[20:23], s49 offen offset:0
v_mfma_f32_16x16x32_bf16 a[12:15], v[8:11], v[36:39], a[12:15]
v_mfma_f32_16x16x32_bf16 a[16:19], v[12:15], v[24:27], a[16:19]
buffer_load_dwordx4 v[76:79], v3, s[24:27], s49 offen offset:1024
v_mfma_f32_16x16x32_bf16 a[20:23], v[12:15], v[28:31], a[20:23]
v_mfma_f32_16x16x32_bf16 a[24:27], v[12:15], v[32:35], a[24:27]
buffer_load_dwordx4 v[92:95], v3, s[20:23], s49 offen offset:1024
v_mfma_f32_16x16x32_bf16 a[28:31], v[12:15], v[36:39], a[28:31]
v_mfma_f32_16x16x32_bf16 a[32:35], v[16:19], v[24:27], a[32:35]
buffer_load_dwordx4 v[80:83], v3, s[24:27], s49 offen offset:2048
v_mfma_f32_16x16x32_bf16 a[36:39], v[16:19], v[28:31], a[36:39]
v_mfma_f32_16x16x32_bf16 a[40:43], v[16:19], v[32:35], a[40:43]
buffer_load_dwordx4 v[96:99], v3, s[20:23], s49 offen offset:2048
v_mfma_f32_16x16x32_bf16 a[44:47], v[16:19], v[36:39], a[44:47]
v_mfma_f32_16x16x32_bf16 a[48:51], v[20:23], v[24:27], a[48:51]
buffer_load_dwordx4 v[84:87], v3, s[24:27], s49 offen offset:3072
v_mfma_f32_16x16x32_bf16 a[52:55], v[20:23], v[28:31], a[52:55]
v_mfma_f32_16x16x32_bf16 a[56:59], v[20:23], v[32:35], a[56:59]
buffer_load_dwordx4 v[100:103], v3, s[20:23], s49 offen offset:3072
v_mfma_f32_16x16x32_bf16 a[60:63], v[20:23], v[36:39], a[60:63]
s_waitcnt vmcnt(8)
s_mov_b32 s48, 49152
v_mfma_f32_16x16x32_bf16 a[0:3], v[40:43], v[56:59], a[0:3]
buffer_load_dwordx4 v[8:11], v3, s[24:27], s48 offen offset:0
v_mfma_f32_16x16x32_bf16 a[4:7], v[40:43], v[60:63], a[4:7]
v_mfma_f32_16x16x32_bf16 a[8:11], v[40:43], v[64:67], a[8:11]
buffer_load_dwordx4 v[24:27], v3, s[20:23], s48 offen offset:0
v_mfma_f32_16x16x32_bf16 a[12:15], v[40:43], v[68:71], a[12:15]
v_mfma_f32_16x16x32_bf16 a[16:19], v[44:47], v[56:59], a[16:19]
buffer_load_dwordx4 v[12:15], v3, s[24:27], s48 offen offset:1024
v_mfma_f32_16x16x32_bf16 a[20:23], v[44:47], v[60:63], a[20:23]
v_mfma_f32_16x16x32_bf16 a[24:27], v[44:47], v[64:67], a[24:27]
buffer_load_dwordx4 v[28:31], v3, s[20:23], s48 offen offset:1024
v_mfma_f32_16x16x32_bf16 a[28:31], v[44:47], v[68:71], a[28:31]
v_mfma_f32_16x16x32_bf16 a[32:35], v[48:51], v[56:59], a[32:35]
buffer_load_dwordx4 v[16:19], v3, s[24:27], s48 offen offset:2048
v_mfma_f32_16x16x32_bf16 a[36:39], v[48:51], v[60:63], a[36:39]
v_mfma_f32_16x16x32_bf16 a[40:43], v[48:51], v[64:67], a[40:43]
buffer_load_dwordx4 v[32:35], v3, s[20:23], s48 offen offset:2048
v_mfma_f32_16x16x32_bf16 a[44:47], v[48:51], v[68:71], a[44:47]
v_mfma_f32_16x16x32_bf16 a[48:51], v[52:55], v[56:59], a[48:51]
buffer_load_dwordx4 v[20:23], v3, s[24:27], s48 offen offset:3072
v_mfma_f32_16x16x32_bf16 a[52:55], v[52:55], v[60:63], a[52:55]
v_mfma_f32_16x16x32_bf16 a[56:59], v[52:55], v[64:67], a[56:59]
buffer_load_dwordx4 v[36:39], v3, s[20:23], s48 offen offset:3072
v_mfma_f32_16x16x32_bf16 a[60:63], v[52:55], v[68:71], a[60:63]
s_waitcnt vmcnt(8)
s_mov_b32 s49, 53248
v_mfma_f32_16x16x32_bf16 a[0:3], v[72:75], v[88:91], a[0:3]
buffer_load_dwordx4 v[40:43], v3, s[24:27], s49 offen offset:0
v_mfma_f32_16x16x32_bf16 a[4:7], v[72:75], v[92:95], a[4:7]
v_mfma_f32_16x16x32_bf16 a[8:11], v[72:75], v[96:99], a[8:11]
buffer_load_dwordx4 v[56:59], v3, s[20:23], s49 offen offset:0
v_mfma_f32_16x16x32_bf16 a[12:15], v[72:75], v[100:103], a[12:15]
v_mfma_f32_16x16x32_bf16 a[16:19], v[76:79], v[88:91], a[16:19]
buffer_load_dwordx4 v[44:47], v3, s[24:27], s49 offen offset:1024
v_mfma_f32_16x16x32_bf16 a[20:23], v[76:79], v[92:95], a[20:23]
v_mfma_f32_16x16x32_bf16 a[24:27], v[76:79], v[96:99], a[24:27]
buffer_load_dwordx4 v[60:63], v3, s[20:23], s49 offen offset:1024
v_mfma_f32_16x16x32_bf16 a[28:31], v[76:79], v[100:103], a[28:31]
v_mfma_f32_16x16x32_bf16 a[32:35], v[80:83], v[88:91], a[32:35]
buffer_load_dwordx4 v[48:51], v3, s[24:27], s49 offen offset:2048
v_mfma_f32_16x16x32_bf16 a[36:39], v[80:83], v[92:95], a[36:39]
v_mfma_f32_16x16x32_bf16 a[40:43], v[80:83], v[96:99], a[40:43]
buffer_load_dwordx4 v[64:67], v3, s[20:23], s49 offen offset:2048
v_mfma_f32_16x16x32_bf16 a[44:47], v[80:83], v[100:103], a[44:47]
v_mfma_f32_16x16x32_bf16 a[48:51], v[84:87], v[88:91], a[48:51]
buffer_load_dwordx4 v[52:55], v3, s[24:27], s49 offen offset:3072
v_mfma_f32_16x16x32_bf16 a[52:55], v[84:87], v[92:95], a[52:55]
v_mfma_f32_16x16x32_bf16 a[56:59], v[84:87], v[96:99], a[56:59]
buffer_load_dwordx4 v[68:71], v3, s[20:23], s49 offen offset:3072
v_mfma_f32_16x16x32_bf16 a[60:63], v[84:87], v[100:103], a[60:63]
s_waitcnt vmcnt(8)
v_mfma_f32_16x16x32_bf16 a[0:3], v[8:11], v[24:27], a[0:3]
v_mfma_f32_16x16x32_bf16 a[4:7], v[8:11], v[28:31], a[4:7]
v_mfma_f32_16x16x32_bf16 a[8:11], v[8:11], v[32:35], a[8:11]
v_mfma_f32_16x16x32_bf16 a[12:15], v[8:11], v[36:39], a[12:15]
v_mfma_f32_16x16x32_bf16 a[16:19], v[12:15], v[24:27], a[16:19]
v_mfma_f32_16x16x32_bf16 a[20:23], v[12:15], v[28:31], a[20:23]
v_mfma_f32_16x16x32_bf16 a[24:27], v[12:15], v[32:35], a[24:27]
v_mfma_f32_16x16x32_bf16 a[28:31], v[12:15], v[36:39], a[28:31]
v_mfma_f32_16x16x32_bf16 a[32:35], v[16:19], v[24:27], a[32:35]
v_mfma_f32_16x16x32_bf16 a[36:39], v[16:19], v[28:31], a[36:39]
v_mfma_f32_16x16x32_bf16 a[40:43], v[16:19], v[32:35], a[40:43]
v_mfma_f32_16x16x32_bf16 a[44:47], v[16:19], v[36:39], a[44:47]
v_mfma_f32_16x16x32_bf16 a[48:51], v[20:23], v[24:27], a[48:51]
v_mfma_f32_16x16x32_bf16 a[52:55], v[20:23], v[28:31], a[52:55]
v_mfma_f32_16x16x32_bf16 a[56:59], v[20:23], v[32:35], a[56:59]
v_mfma_f32_16x16x32_bf16 a[60:63], v[20:23], v[36:39], a[60:63]
s_waitcnt vmcnt(0)
v_mfma_f32_16x16x32_bf16 a[0:3], v[40:43], v[56:59], a[0:3]
v_mfma_f32_16x16x32_bf16 a[4:7], v[40:43], v[60:63], a[4:7]
v_mfma_f32_16x16x32_bf16 a[8:11], v[40:43], v[64:67], a[8:11]
v_mfma_f32_16x16x32_bf16 a[12:15], v[40:43], v[68:71], a[12:15]
v_mfma_f32_16x16x32_bf16 a[16:19], v[44:47], v[56:59], a[16:19]
v_mfma_f32_16x16x32_bf16 a[20:23], v[44:47], v[60:63], a[20:23]
v_mfma_f32_16x16x32_bf16 a[24:27], v[44:47], v[64:67], a[24:27]
v_mfma_f32_16x16x32_bf16 a[28:31], v[44:47], v[68:71], a[28:31]
v_mfma_f32_16x16x32_bf16 a[32:35], v[48:51], v[56:59], a[32:35]
v_mfma_f32_16x16x32_bf16 a[36:39], v[48:51], v[60:63], a[36:39]
v_mfma_f32_16x16x32_bf16 a[40:43], v[48:51], v[64:67], a[40:43]
v_mfma_f32_16x16x32_bf16 a[44:47], v[48:51], v[68:71], a[44:47]
v_mfma_f32_16x16x32_bf16 a[48:51], v[52:55], v[56:59], a[48:51]
v_mfma_f32_16x16x32_bf16 a[52:55], v[52:55], v[60:63], a[52:55]
v_mfma_f32_16x16x32_bf16 a[56:59], v[52:55], v[64:67], a[56:59]
v_mfma_f32_16x16x32_bf16 a[60:63], v[52:55], v[68:71], a[60:63]
s_nop 7
s_nop 1
s_lshl_b32 s38, s9, 12
v_add_u32 v8, s38, v3
s_cmp_eq_u32 s9, 0
s_cbranch_scc1 L_skipw_18
ds_write_b128 v8, a[0:3] offset:0
ds_write_b128 v8, a[16:19] offset:1024
ds_write_b128 v8, a[32:35] offset:2048
ds_write_b128 v8, a[48:51] offset:3072
L_skipw_18:
s_cmp_eq_u32 s9, 1
s_cbranch_scc1 L_skipw_19
ds_write_b128 v8, a[4:7] offset:16384
ds_write_b128 v8, a[20:23] offset:17408
ds_write_b128 v8, a[36:39] offset:18432
ds_write_b128 v8, a[52:55] offset:19456
L_skipw_19:
s_cmp_eq_u32 s9, 2
s_cbranch_scc1 L_skipw_20
ds_write_b128 v8, a[8:11] offset:32768
ds_write_b128 v8, a[24:27] offset:33792
ds_write_b128 v8, a[40:43] offset:34816
ds_write_b128 v8, a[56:59] offset:35840
L_skipw_20:
s_cmp_eq_u32 s9, 3
s_cbranch_scc1 L_skipw_21
ds_write_b128 v8, a[12:15] offset:49152
ds_write_b128 v8, a[28:31] offset:50176
ds_write_b128 v8, a[44:47] offset:51200
ds_write_b128 v8, a[60:63] offset:52224
L_skipw_21:
s_cmp_lg_u32 s9, 0
s_cbranch_scc1 L_skipo_22
v_accvgpr_read_b32 v16, a0
v_accvgpr_read_b32 v17, a1
v_accvgpr_read_b32 v18, a2
v_accvgpr_read_b32 v19, a3
v_accvgpr_read_b32 v20, a16
v_accvgpr_read_b32 v21, a17
v_accvgpr_read_b32 v22, a18
v_accvgpr_read_b32 v23, a19
v_accvgpr_read_b32 v24, a32
v_accvgpr_read_b32 v25, a33
v_accvgpr_read_b32 v26, a34
v_accvgpr_read_b32 v27, a35
v_accvgpr_read_b32 v28, a48
v_accvgpr_read_b32 v29, a49
v_accvgpr_read_b32 v30, a50
v_accvgpr_read_b32 v31, a51
L_skipo_22:
s_cmp_lg_u32 s9, 1
s_cbranch_scc1 L_skipo_23
v_accvgpr_read_b32 v16, a4
v_accvgpr_read_b32 v17, a5
v_accvgpr_read_b32 v18, a6
v_accvgpr_read_b32 v19, a7
v_accvgpr_read_b32 v20, a20
v_accvgpr_read_b32 v21, a21
v_accvgpr_read_b32 v22, a22
v_accvgpr_read_b32 v23, a23
v_accvgpr_read_b32 v24, a36
v_accvgpr_read_b32 v25, a37
v_accvgpr_read_b32 v26, a38
v_accvgpr_read_b32 v27, a39
v_accvgpr_read_b32 v28, a52
v_accvgpr_read_b32 v29, a53
v_accvgpr_read_b32 v30, a54
v_accvgpr_read_b32 v31, a55
L_skipo_23:
s_cmp_lg_u32 s9, 2
s_cbranch_scc1 L_skipo_24
v_accvgpr_read_b32 v16, a8
v_accvgpr_read_b32 v17, a9
v_accvgpr_read_b32 v18, a10
v_accvgpr_read_b32 v19, a11
v_accvgpr_read_b32 v20, a24
v_accvgpr_read_b32 v21, a25
v_accvgpr_read_b32 v22, a26
v_accvgpr_read_b32 v23, a27
v_accvgpr_read_b32 v24, a40
v_accvgpr_read_b32 v25, a41
v_accvgpr_read_b32 v26, a42
v_accvgpr_read_b32 v27, a43
v_accvgpr_read_b32 v28, a56
v_accvgpr_read_b32 v29, a57
v_accvgpr_read_b32 v30, a58
v_accvgpr_read_b32 v31, a59
L_skipo_24:
s_cmp_lg_u32 s9, 3
s_cbranch_scc1 L_skipo_25
v_accvgpr_read_b32 v16, a12
v_accvgpr_read_b32 v17, a13
v_accvgpr_read_b32 v18, a14
v_accvgpr_read_b32 v19, a15
v_accvgpr_read_b32 v20, a28
v_accvgpr_read_b32 v21, a29
v_accvgpr_read_b32 v22, a30
v_accvgpr_read_b32 v23, a31
v_accvgpr_read_b32 v24, a44
v_accvgpr_read_b32 v25, a45
v_accvgpr_read_b32 v26, a46
v_accvgpr_read_b32 v27, a47
v_accvgpr_read_b32 v28, a60
v_accvgpr_read_b32 v29, a61
v_accvgpr_read_b32 v30, a62
v_accvgpr_read_b32 v31, a63
L_skipo_25:
v_and_b32 v5, 15, v2
v_lshlrev_b32 v5, 10, v5
v_lshrrev_b32 v12, 4, v2
v_lshlrev_b32 v12, 4, v12
v_add_u32 v5, v5, v12
s_lshl_b32 s42, s8, 16
s_lshl_b32 s43, s9, 14
s_add_u32 s42, s42, s43
s_lshl_b32 s43, s10, 7
s_add_u32 s42, s42, s43
s_mov_b32 s44, s6
s_and_b32 s45, s7, 0xffff
s_mov_b32 s46, 2097152
s_mov_b32 s47, 0x20000
s_waitcnt vmcnt(0) lgkmcnt(0)
s_barrier
s_lshl_b32 s38, s9, 14
v_add_u32 v8, s38, v3
s_add_u32 s39, s9, 1
s_and_b32 s39, s39, 3
s_lshl_b32 s39, s39, 12
v_add_u32 v9, s39, v8
s_add_u32 s39, s9, 2
s_and_b32 s39, s39, 3
s_lshl_b32 s39, s39, 12
v_add_u32 v10, s39, v8
s_add_u32 s39, s9, 3
s_and_b32 s39, s39, 3
s_lshl_b32 s39, s39, 12
v_add_u32 v11, s39, v8
ds_read_b128 v[32:35], v9 offset:0
ds_read_b128 v[36:39], v9 offset:1024
ds_read_b128 v[40:43], v9 offset:2048
ds_read_b128 v[44:47], v9 offset:3072
ds_read_b128 v[48:51], v10 offset:0
ds_read_b128 v[52:55], v10 offset:1024
ds_read_b128 v[56:59], v10 offset:2048
ds_read_b128 v[60:63], v10 offset:3072
ds_read_b128 v[64:67], v11 offset:0
ds_read_b128 v[68:71], v11 offset:1024
ds_read_b128 v[72:75], v11 offset:2048
ds_read_b128 v[76:79], v11 offset:3072
s_waitcnt lgkmcnt(8)
v_add_f32 v16, v16, v32
v_add_f32 v17, v17, v33
v_add_f32 v18, v18, v34
v_add_f32 v19, v19, v35
v_add_f32 v20, v20, v36
v_add_f32 v21, v21, v37
v_add_f32 v22, v22, v38
v_add_f32 v23, v23, v39
v_add_f32 v24, v24, v40
v_add_f32 v25, v25, v41
v_add_f32 v26, v26, v42
v_add_f32 v27, v27, v43
v_add_f32 v28, v28, v44
v_add_f32 v29, v29, v45
v_add_f32 v30, v30, v46
v_add_f32 v31, v31, v47
s_waitcnt lgkmcnt(4)
v_add_f32 v16, v16, v48
v_add_f32 v17, v17, v49
v_add_f32 v18, v18, v50
v_add_f32 v19, v19, v51
v_add_f32 v20, v20, v52
v_add_f32 v21, v21, v53
v_add_f32 v22, v22, v54
v_add_f32 v23, v23, v55
v_add_f32 v24, v24, v56
v_add_f32 v25, v25, v57
v_add_f32 v26, v26, v58
v_add_f32 v27, v27, v59
v_add_f32 v28, v28, v60
v_add_f32 v29, v29, v61
v_add_f32 v30, v30, v62
v_add_f32 v31, v31, v63
s_waitcnt lgkmcnt(0)
v_add_f32 v16, v16, v64
v_add_f32 v17, v17, v65
v_add_f32 v18, v18, v66
v_add_f32 v19, v19, v67
v_add_f32 v20, v20, v68
v_add_f32 v21, v21, v69
v_add_f32 v22, v22, v70
v_add_f32 v23, v23, v71
v_add_f32 v24, v24, v72
v_add_f32 v25, v25, v73
v_add_f32 v26, v26, v74
v_add_f32 v27, v27, v75
v_add_f32 v28, v28, v76
v_add_f32 v29, v29, v77
v_add_f32 v30, v30, v78
v_add_f32 v31, v31, v79
v_sub_f32 v8, 1.0, v7
v_cvt_pk_bf16_f32 v8, v8, v8
v_and_b32 v8, 0xffff0000, v8
s_waitcnt lgkmcnt(0)
s_mov_b32 s40, 0xffff0000
v_cvt_pk_bf16_f32 v16, 0, v16
v_cvt_pk_bf16_f32 v17, 0, v17
v_mul_f32 v16, v8, v16
v_mul_f32 v17, v8, v17
v_cvt_pk_bf16_f32 v16, 0, v16
v_cvt_pk_bf16_f32 v17, 0, v17
v_add_f32 v16, v104, v16
v_add_f32 v17, v105, v17
v_cvt_pk_bf16_f32 v88, v16, v17
v_cvt_pk_bf16_f32 v18, 0, v18
v_cvt_pk_bf16_f32 v19, 0, v19
v_mul_f32 v18, v8, v18
v_mul_f32 v19, v8, v19
v_cvt_pk_bf16_f32 v18, 0, v18
v_cvt_pk_bf16_f32 v19, 0, v19
v_add_f32 v18, v106, v18
v_add_f32 v19, v107, v19
v_cvt_pk_bf16_f32 v89, v18, v19
v_cvt_pk_bf16_f32 v20, 0, v20
v_cvt_pk_bf16_f32 v21, 0, v21
v_mul_f32 v20, v8, v20
v_mul_f32 v21, v8, v21
v_cvt_pk_bf16_f32 v20, 0, v20
v_cvt_pk_bf16_f32 v21, 0, v21
v_add_f32 v20, v108, v20
v_add_f32 v21, v109, v21
v_cvt_pk_bf16_f32 v90, v20, v21
v_cvt_pk_bf16_f32 v22, 0, v22
v_cvt_pk_bf16_f32 v23, 0, v23
v_mul_f32 v22, v8, v22
v_mul_f32 v23, v8, v23
v_cvt_pk_bf16_f32 v22, 0, v22
v_cvt_pk_bf16_f32 v23, 0, v23
v_add_f32 v22, v110, v22
v_add_f32 v23, v111, v23
v_cvt_pk_bf16_f32 v91, v22, v23
v_cvt_pk_bf16_f32 v24, 0, v24
v_cvt_pk_bf16_f32 v25, 0, v25
v_mul_f32 v24, v8, v24
v_mul_f32 v25, v8, v25
v_cvt_pk_bf16_f32 v24, 0, v24
v_cvt_pk_bf16_f32 v25, 0, v25
v_add_f32 v24, v112, v24
v_add_f32 v25, v113, v25
v_cvt_pk_bf16_f32 v92, v24, v25
v_cvt_pk_bf16_f32 v26, 0, v26
v_cvt_pk_bf16_f32 v27, 0, v27
v_mul_f32 v26, v8, v26
v_mul_f32 v27, v8, v27
v_cvt_pk_bf16_f32 v26, 0, v26
v_cvt_pk_bf16_f32 v27, 0, v27
v_add_f32 v26, v114, v26
v_add_f32 v27, v115, v27
v_cvt_pk_bf16_f32 v93, v26, v27
v_cvt_pk_bf16_f32 v28, 0, v28
v_cvt_pk_bf16_f32 v29, 0, v29
v_mul_f32 v28, v8, v28
v_mul_f32 v29, v8, v29
v_cvt_pk_bf16_f32 v28, 0, v28
v_cvt_pk_bf16_f32 v29, 0, v29
v_add_f32 v28, v116, v28
v_add_f32 v29, v117, v29
v_cvt_pk_bf16_f32 v94, v28, v29
v_cvt_pk_bf16_f32 v30, 0, v30
v_cvt_pk_bf16_f32 v31, 0, v31
v_mul_f32 v30, v8, v30
v_mul_f32 v31, v8, v31
v_cvt_pk_bf16_f32 v30, 0, v30
v_cvt_pk_bf16_f32 v31, 0, v31
v_add_f32 v30, v118, v30
v_add_f32 v31, v119, v31
v_cvt_pk_bf16_f32 v95, v30, v31
buffer_store_dwordx4 v[88:91], v5, s[44:47], s42 offen sc0 sc1
buffer_store_dwordx4 v[92:95], v5, s[44:47], s42 offen offset:64 sc0 sc1
L_kb_end_17:
s_endpgm
.section .rodata,"a"
.p2align 6
.amdhsa_kernel ka_kernel
.amdhsa_next_free_vgpr 256
.amdhsa_next_free_sgpr 102
.amdhsa_accum_offset 256
.amdhsa_group_segment_fixed_size 0
.amdhsa_kernarg_size 128
.amdhsa_user_sgpr_count 2
.amdhsa_user_sgpr_kernarg_segment_ptr 1
.amdhsa_system_sgpr_workgroup_id_x 1
.amdhsa_float_denorm_mode_32 3
.amdhsa_float_denorm_mode_16_64 3
.end_amdhsa_kernel
.p2align 6
.amdhsa_kernel kb_kernel
.amdhsa_next_free_vgpr 320
.amdhsa_next_free_sgpr 102
.amdhsa_accum_offset 256
.amdhsa_group_segment_fixed_size 0
.amdhsa_kernarg_size 128
.amdhsa_user_sgpr_count 2
.amdhsa_user_sgpr_kernarg_segment_ptr 1
.amdhsa_system_sgpr_workgroup_id_x 1
.amdhsa_float_denorm_mode_32 3
.amdhsa_float_denorm_mode_16_64 3
.end_amdhsa_kernel
```
